```python
import torch

def _softmax(x, axis=-1):
    return torch.softmax(x, dim=axis)
def _gelu(x):
    return torch.nn.functional.gelu(x, approximate="tanh")
def _silu(x):
    return torch.nn.functional.silu(x)
def _sigmoid(x):
    return torch.sigmoid(x)
def _layernorm(x, axis=-1, eps=1e-5):
    m = x.mean(dim=axis, keepdim=True)
    v = x.var(dim=axis, keepdim=True, unbiased=False)
    return (x - m) / torch.sqrt(v + eps)
def _scatter_add(tgt, idx, src, axis=0):
    return tgt.clone().index_add_(axis, idx, src)
def _segment_sum(src, seg, n):
    out = torch.zeros((n,) + src.shape[1:], dtype=src.dtype)
    return out.index_add_(0, seg, src)
def _pad(x, pw):
    flat = tuple(v for pair in reversed(pw) for v in pair)
    return torch.nn.functional.pad(x, flat)

kernel_name = 'parallel_sum__ssm_conv_s5__dense_activation_mish__prompt'

def setup_inputs():

    _w = (lambda a: (lambda t: t.to(torch.bfloat16) if t.is_floating_point() else t)(torch.as_tensor(a)))
    def _A_setup():
        B, S, D = 1, 2048, 448
        P = D
        Lambda_re = -0.5 * (lambda _x: torch.exp(torch.as_tensor(_x)))((lambda *s: torch.randn(*s, dtype=torch.bfloat16) * 0.2)(P))
        Lambda_im = (lambda *s: torch.randn(*s, dtype=torch.bfloat16) * 0.8)(P) * 1.0
        B_re = (lambda *s: torch.randn(*s, dtype=torch.bfloat16) * 0.2)(P, D) * (D ** -0.5)
        B_im = (lambda *s: torch.randn(*s, dtype=torch.bfloat16) * 0.2)(P, D) * (D ** -0.5)
        C_re = (lambda *s: torch.randn(*s, dtype=torch.bfloat16) * 0.2)(D, P) * (P ** -0.5)
        C_im = (lambda *s: torch.randn(*s, dtype=torch.bfloat16) * 0.2)(D, P) * (P ** -0.5)
        log_dt = (lambda *s: torch.randn(*s, dtype=torch.bfloat16) * 0.2)(P) * 0.3 - 2.0
        Dskip = (lambda *s: torch.randn(*s, dtype=torch.bfloat16) * 0.05)(D)
        return {
            "x": _w((lambda *s: torch.randn(*s, dtype=torch.bfloat16) * 0.05)(B, S, D)),
            "Lambda_re": _w(Lambda_re),
            "Lambda_im": _w(Lambda_im),
            "B_re": _w(B_re),
            "B_im": _w(B_im),
            "C_re": _w(C_re),
            "C_im": _w(C_im),
            "log_dt": _w(log_dt),
            "Dskip": _w(Dskip),
        }
    _A_in = _A_setup()

    def _B_setup():
        B, S, D, F = 1, 2048, 448, 1792
        return {
            "x": _w((lambda *s: torch.randn(*s, dtype=torch.bfloat16) * 0.05)(B, S, D)),
            "w1": _w((lambda *s: torch.randn(*s, dtype=torch.bfloat16) * 0.8)(D, F) * (D ** -0.5)),
            "b1": _w((lambda *s: torch.randn(*s, dtype=torch.bfloat16) * 0.2)(F)),
            "w2": _w((lambda *s: torch.randn(*s, dtype=torch.bfloat16) * 0.2)(F, D) * (F ** -0.5)),
        }
    _B_in = _B_setup()

    return {
        "A_x": _A_in["x"],
        "A_Lambda_re": _A_in["Lambda_re"],
        "A_Lambda_im": _A_in["Lambda_im"],
        "A_B_re": _A_in["B_re"],
        "A_B_im": _A_in["B_im"],
        "A_C_re": _A_in["C_re"],
        "A_C_im": _A_in["C_im"],
        "A_log_dt": _A_in["log_dt"],
        "A_Dskip": _A_in["Dskip"],
        "B_x": _B_in["x"],
        "B_w1": _B_in["w1"],
        "B_b1": _B_in["b1"],
        "B_w2": _B_in["w2"],
    }

def reference(A_x, A_Lambda_re, A_Lambda_im, A_B_re, A_B_im, A_C_re, A_C_im, A_log_dt, A_Dskip, B_x, B_w1, B_b1, B_w2):
    def _A_ref(x, Lambda_re, Lambda_im, B_re, B_im, C_re, C_im, log_dt, Dskip):
        Bsz, L, H = x.shape
        Lam = Lambda_re + 1j * Lambda_im
        Bmat = B_re + 1j * B_im
        Cmat = C_re + 1j * C_im
        dt = torch.exp(log_dt)
        Lam_bar = torch.exp(dt * Lam)
        B_bar = ((Lam_bar - 1.0) / Lam)[:, None] * Bmat
        Bu = torch.einsum("bld,pd->blp", x + 0j, B_bar)
        h = torch.zeros_like(Bu[:, 0, :])
        hs = []
        for t in range(L):
            h = Lam_bar[None, :] * h + Bu[:, t, :]
            hs.append(h)
        hseq = torch.stack(hs, 1)
        y = 2.0 * torch.einsum("blp,dp->bld", hseq, Cmat).real + x * Dskip[None, None, :]
        return y

    def _B_ref(x, w1, b1, w2):
        h = torch.einsum("bsd,df->bsf", x, w1) + b1
        sp = torch.log1p(torch.exp(-torch.abs(h))) + torch.where(h > 0, h, torch.zeros_like(h))
        act = h * torch.tanh(sp)
        return torch.einsum("bsf,fd->bsd", act, w2)

    x = A_x
    xn = _layernorm(x, axis=-1)
    return x + _A_ref(xn, A_Lambda_re, A_Lambda_im, A_B_re, A_B_im, A_C_re, A_C_im, A_log_dt, A_Dskip) + _B_ref(xn, B_w1, B_b1, B_w2)
```

```asm
; @launch grid=(256,1,1) block=(256,1,1) lds=156672
.amdgcn_target "amdgcn-amd-amdhsa--gfx950"
.text
.globl parallel_sum__ssm_conv_s5__dense_activation_mish__prompt_kernel
.p2align 12
.p2align 8
.type parallel_sum__ssm_conv_s5__dense_activation_mish__prompt_kernel,@function
parallel_sum__ssm_conv_s5__dense_activation_mish__prompt_kernel:
    s_load_dwordx2 s[48:49], s[0:1], 0
    s_load_dwordx16 s[16:31], s[0:1], 0
    s_load_dwordx16 s[32:47], s[0:1], 64
    s_cmp_ge_u32 s2, 256
    s_cbranch_scc1 L_exit
    s_getpc_b64 s[4:5]
L_pc:
    s_and_b32 s13, s2, 0xf8
    v_lshrrev_b32 v1, 5, v0
    v_add_lshl_u32 v2, s13, v1, 7
    v_min_u32 v2, L_end-L_pc-4, v2
    v_mov_b32 v3, s5
    v_add_co_u32 v2, vcc, s4, v2
    v_lshrrev_b32 v1, 1, v1
    v_and_b32 v0, 63, v0
    v_addc_co_u32 v3, vcc, 0, v3, vcc
    v_readfirstlane_b32 s3, v1
    global_load_dword v216, v[2:3], off
    s_cmp_lt_u32 s2, 32
    s_cbranch_scc1 L_helper
    s_and_b32 s13, s2, 1
    s_mul_i32 s13, s13, 28
    s_lshr_b32 s14, s2, 3
    s_add_u32 s13, s13, s14
    s_sub_u32 s13, s13, 4
    s_lshr_b32 s5, s13, 3
    s_and_b32 s13, s13, 7
    s_and_b32 s14, s2, 6
    s_lshl2_add_u32 s4, s14, s13
    s_lshl1_add_u32 s13, s5, s4
    s_mul_i32 s14, s13, 37
    s_lshr_b32 s14, s14, 8
    s_mul_i32 s14, s14, 7
    s_sub_u32 s13, s13, s14
    s_lshl_b32 s88, s13, 7
    s_mov_b32 s50, 1835008
    s_mov_b32 s51, 0x20000
    v_and_b32 v241, 7, v0
    v_lshrrev_b32 v245, 4, v0
    v_lshrrev_b32 v243, 5, v0
    s_lshl_b32 s8, s3, 11
    s_lshl_b32 s13, s4, 6
    s_lshl1_add_u32 s13, s3, s13
    v_and_or_b32 v240, v0, 8, s13
    v_and_or_b32 v240, v245, 1, v240
    v_lshl_add_u32 v240, v243, 4, v240
    v_xor_b32 v242, v245, v241
    v_mul_u32_u24 v1, 896, v240
    v_lshl_add_u32 v1, v242, 4, v1
    v_add_u32 v210, 27648, v1
    v_xor_b32 v210, 64, v210
    s_add_u32 s89, s88, 128
    s_cmp_eq_u32 s89, 896
    s_cselect_b32 s89, 0, s89
    s_add_u32 m0, s8, 0
    s_waitcnt lgkmcnt(0)
    buffer_load_dwordx4 v1, s[48:51], s88 offen offset:0  lds
    buffer_load_dwordx4 v210, s[48:51], s88 offen offset:1024  lds
    s_add_u32 m0, s8, 8192
    s_nop 0
    buffer_load_dwordx4 v1, s[48:51], s89 offen offset:0  lds
    buffer_load_dwordx4 v210, s[48:51], s89 offen offset:1024  lds
    s_lshl2_add_u32 s15, s5, s3
    s_lshl3_add_u32 s12, s5, s3
    s_lshl_b32 s12, s12, 6
    s_lshl_b32 s13, s15, 5
    v_and_b32 v244, 15, v0
    v_lshl_add_u32 v64, v244, 1, s13
    v_and_b32 v240, 31, v0
    v_lshl_add_u32 v65, v240, 1, s12
    v_lshl_add_u32 v65, v243, 8, v65
    s_and_b32 s14, s3, 1
    s_lshl1_add_u32 s13, s5, s14
    s_lshl_b32 s13, s13, 6
    s_nop 0
    v_lshl_add_u32 v66, v244, 1, s13
    global_load_ushort v248, v64, s[18:19]
    global_load_ushort v249, v64, s[20:21]
    global_load_ushort v250, v64, s[30:31]
    global_load_ushort v208, v65, s[38:39]
    global_load_ushort v212, v66, s[32:33]
    global_load_ushort v213, v66, s[32:33] offset:32
    s_add_u32 s90, s89, 128
    s_cmp_eq_u32 s90, 896
    s_cselect_b32 s90, 0, s90
    s_add_u32 s91, s90, 128
    s_cmp_eq_u32 s91, 896
    s_cselect_b32 s91, 0, s91
    s_add_u32 s92, s91, 128
    s_cmp_eq_u32 s92, 896
    s_cselect_b32 s92, 0, s92
    s_add_u32 s93, s92, 128
    s_cmp_eq_u32 s93, 896
    s_cselect_b32 s93, 0, s93
    s_add_u32 s94, s93, 128
    s_cmp_eq_u32 s94, 896
    s_cselect_b32 s94, 0, s94
    s_mul_i32 s6, s3, 24576
    s_add_u32 s6, s6, 58368
    s_mul_i32 s11, s15, 14336
    s_add_u32 s52, s22, s11
    s_addc_u32 s53, s23, 0
    s_add_u32 s56, s24, s11
    s_addc_u32 s57, s25, 0
    v_lshrrev_b32 v240, 3, v0
    v_mul_u32_u24 v4, 896, v240
    v_lshl_add_u32 v4, v242, 4, v4
    v_add_u32 v5, 6144, v4
    v_xor_b32 v5, 64, v5
    s_mov_b32 s54, 14336
    s_mov_b32 s55, 0x20000
    s_mov_b32 s58, 14336
    s_mov_b32 s59, 0x20000
    s_add_u32 m0, s8, 16384
    s_nop 0
    buffer_load_dwordx4 v1, s[48:51], s90 offen offset:0  lds
    buffer_load_dwordx4 v210, s[48:51], s90 offen offset:1024  lds
    s_mov_b64 s[60:61], s[26:27]
    s_mov_b64 s[64:65], s[28:29]
    s_mov_b64 s[72:73], s[40:41]
    s_mov_b64 s[76:77], s[42:43]
    s_mov_b64 s[80:81], s[46:47]
    s_nop 0
    s_mov_b32 s62, 401408
    s_mov_b32 s63, 0x20000
    s_mov_b32 s66, 401408
    s_mov_b32 s67, 0x20000
    s_mov_b32 s74, 1605632
    s_mov_b32 s75, 0x20000
    s_mov_b32 s78, 3670016
    s_mov_b32 s79, 0x20000
    s_mov_b32 s82, 16777216
    s_mov_b32 s83, 0x20000
    s_mov_b32 s86, 4096
    s_mov_b32 s87, 0x20000
    s_add_u32 s68, s36, s12
    s_addc_u32 s69, s37, 0
    s_mov_b32 s70, 1602112
    s_mov_b32 s71, 0x20000
    s_lshl_b32 s13, s15, 12
    s_add_u32 s84, s80, s13
    s_addc_u32 s85, s81, 0
    s_mov_b32 s10, 0x3fb8aa3b
    s_mov_b32 s34, 400000
    s_mov_b32 s9, 0x3f803f80
    v_lshl_add_u32 v3, v0, 4, s8
    v_add_u32 v6, 12288, v4
    v_add_u32 v7, 12288, v5
    s_lshl_b32 s13, s3, 2
    v_and_or_b32 v2, v240, 3, s13
    v_lshl_add_u32 v2, v243, 4, v2
    v_and_b32 v242, 4, v0
    v_lshl_add_u32 v2, v242, 3, v2
    v_bfe_u32 v242, v0, 1, 1
    v_add_u32 v240, 2, v242
    v_lshlrev_b32 v2, v240, v2
    v_lshl_add_u32 v2, v242, 9, v2
    v_mul_u32_u24 v242, 6, v242
    v_sub_u32 v242, 8, v242
    v_and_b32 v240, 1, v0
    v_lshlrev_b32 v240, v242, v240
    v_add_u32 v2, v240, v2
    v_bfe_i32 v240, v0, 0, 1
    v_and_b32 v240, 0xaaaaaaaa, v240
    v_or_b32 v209, 0x44444444, v240
    v_mov_b32 v176, s9
    v_mov_b32 v177, s9
    v_mov_b32 v178, s9
    v_mov_b32 v179, s9
    v_mov_b32 v180, 0
    v_mov_b32 v181, 0
    v_mov_b32 v182, 0
    v_mov_b32 v183, 0
    v_mov_b32 v184, 0
    v_mov_b32 v185, 0
    v_mov_b32 v186, 0
    v_mov_b32 v187, 0
    v_mov_b32 v188, 0
    v_mov_b32 v189, 0
    v_mov_b32 v190, 0
    v_mov_b32 v191, 0
    v_mov_b32 v192, 0
    v_mov_b32 v193, 0
    v_mov_b32 v194, 0
    v_mov_b32 v195, 0
    v_bfe_u32 v242, v0, 1, 3
    v_xor_b32 v242, v242, v245
    v_lshlrev_b32 v22, 4, v242
    v_lshl_add_u32 v22, v244, 7, v22
    v_xor_b32 v23, 64, v22
    v_add_u32 v16, s6, v22
    v_xor_b32 v17, 64, v16
    s_sub_u32 s13, 31, s4
    s_lshl_b32 s13, s13, 7
    v_lshl_add_u32 v43, v244, 3, s13
    v_lshl_add_u32 v42, v245, 10, v43
    v_add_u32 v42, 128, v42
    v_lshl_add_u32 v43, v245, 12, v43
    v_lshrrev_b32 v240, 2, v0
    v_and_b32 v241, 3, v0
    v_lshlrev_b32 v242, 1, v243
    v_xor_b32 v242, v242, v241
    v_mul_u32_u24 v8, 3584, v240
    v_lshl_add_u32 v8, v242, 4, v8
    v_and_b32 v244, 1, v245
    v_lshlrev_b32 v242, 1, v244
    v_xor_b32 v242, v242, v241
    v_mul_u32_u24 v12, 896, v240
    v_lshl_add_u32 v12, v242, 4, v12
    v_add_u32 v9, 56320, v8
    v_add_u32 v13, 13312, v12
    v_add_u32 v10, 112640, v8
    v_add_u32 v14, 26624, v12
    v_add_u32 v11, 168960, v8
    v_add_u32 v15, 39936, v12
    v_lshl_add_u32 v20, v241, 3, s6
    v_lshl_add_u32 v20, v244, 5, v20
    v_and_b32 v242, 3, v240
    v_lshl_add_u32 v18, v242, 6, v20
    v_lshl_add_u32 v18, v245, 9, v18
    v_lshl_add_u32 v20, v240, 6, v20
    v_xor_b32 v19, 32, v18
    v_xor_b32 v21, 32, v20
    s_and_b32 s47, s4, 3
    s_and_b32 s14, s3, 1
    s_lshl1_add_u32 s13, s5, s14
    s_mul_i32 s14, s4, 112
    s_mul_i32 s15, s5, 229376
    s_lshl_b32 s28, s5, 7
    s_lshl3_add_u32 s27, s13, s14
    s_lshl_b32 s95, s13, 6
    s_add_u32 s19, s15, s95
    s_mul_i32 s95, s13, 28672
    s_add_u32 s23, s95, s28
    s_and_b32 s95, s3, 2
    s_add_u32 s13, s13, s95
    s_lshr_b32 s95, s95, 1
    s_add_u32 s14, s14, s95
    s_add_u32 s13, s13, 2
    s_cmp_ge_u32 s13, 14
    s_cselect_b32 s95, 14, 0
    s_sub_u32 s13, s13, s95
    s_lshl3_add_u32 s24, s13, s14
    s_lshl_b32 s95, s13, 6
    s_add_u32 s16, s15, s95
    s_mul_i32 s95, s13, 28672
    s_add_u32 s20, s95, s28
    s_add_u32 s13, s13, 4
    s_cmp_ge_u32 s13, 14
    s_cselect_b32 s95, 14, 0
    s_sub_u32 s13, s13, s95
    s_lshl3_add_u32 s25, s13, s14
    s_lshl_b32 s95, s13, 6
    s_add_u32 s17, s15, s95
    s_mul_i32 s95, s13, 28672
    s_add_u32 s21, s95, s28
    s_add_u32 s13, s13, 4
    s_cmp_ge_u32 s13, 14
    s_cselect_b32 s95, 14, 0
    s_sub_u32 s13, s13, s95
    s_lshl3_add_u32 s26, s13, s14
    s_lshl_b32 s95, s13, 6
    s_add_u32 s18, s15, s95
    s_mul_i32 s95, s13, 28672
    s_add_u32 s22, s95, s28
    s_lshr_b32 s35, s88, 7
    s_sub_u32 s35, s5, s35
    s_add_u32 s35, s35, 7
    s_cmp_ge_u32 s35, 7
    s_cselect_b32 s95, 7, 0
    s_sub_u32 s35, s35, s95
    s_and_b32 s15, s3, 2
    s_lshl_b32 s13, s15, 3
    v_bfe_u32 v32, v0, 3, 2
    v_and_or_b32 v32, v0, 4, v32
    v_lshlrev_b32 v241, 2, v241
    v_xor_b32 v32, v32, v241
    v_lshlrev_b32 v32, 3, v32
    v_lshl_add_u32 v32, v242, 7, v32
    v_lshl_add_u32 v32, v245, 10, v32
    v_xor_b32 v32, s13, v32
    v_xor_b32 v33, 64, v32
    v_xor_b32 v34, 8, v32
    v_xor_b32 v35, 72, v32
    v_xor_b32 v36, 16, v32
    v_xor_b32 v37, 80, v32
    v_xor_b32 v38, 24, v32
    v_xor_b32 v39, 88, v32
    v_bfe_u32 v28, v0, 1, 1
    v_and_or_b32 v28, v240, 2, v28
    v_lshlrev_b32 v242, 2, v0
    v_and_or_b32 v28, v242, 4, v28
    v_lshlrev_b32 v242, 1, v0
    v_and_or_b32 v28, v242, 8, v28
    v_lshlrev_b32 v242, 2, v245
    v_xor_b32 v28, v28, v242
    v_lshl_add_u32 v28, v28, 3, s8
    v_and_b32 v242, 15, v0
    v_lshl_add_u32 v28, v242, 7, v28
    v_xor_b32 v29, 8, v28
    v_xor_b32 v30, 16, v28
    v_xor_b32 v31, 24, v28
    s_lshl_b32 s13, s15, 10
    v_lshl_add_u32 v24, v0, 4, s13
    v_xor_b32 v25, 0x800, v24
    s_lshl_b32 s13, s47, 1
    s_xor_b32 s13, s13, s3
    s_lshl_b32 s13, s13, 12
    v_lshl_add_u32 v26, v0, 4, s13
    v_xor_b32 v27, 0x4000, v26
    v_and_b32 v240, 12, v0
    v_and_b32 v241, 3, v0
    v_lshl_add_u32 v241, v240, 2, v241
    v_lshlrev_b32 v240, 3, v241
    v_add_u32 v240, 57856, v240
    v_lshlrev_b32 v241, 2, v241
    v_add_u32 v241, 57600, v241
    v_and_b32 v242, 48, v0
    s_and_b32 s15, s3, 2
    s_lshl2_add_u32 s14, s35, s15
    s_lshl_b32 s14, s14, 11
    s_and_b32 s13, s3, 1
    s_lshl_b32 s13, s13, 5
    v_xor_b32 v244, s13, v0
    v_lshl_add_u32 v244, v244, 1, s14
    v_lshl_add_u32 v244, v242, 5, v244
    v_xor_b32 v245, 16, v244
    v_xor_b32 v246, 32, v244
    v_xor_b32 v247, 48, v244
    v_lshlrev_b32 v242, 2, v242
    v_lshl_add_u32 v211, s15, 4, v242
    v_add_u32 v253, -16, v0
    v_ashrrev_i32 v253, 31, v253
    v_or_b32 v254, 0xffff0000, v253
    s_mov_b64 exec, 0
    s_cmp_eq_u32 s3, 0
    s_cbranch_scc1 L_pg1
    s_cmp_eq_u32 s3, 1
    s_cbranch_scc1 L_pg2
    s_cmp_eq_u32 s3, 2
    s_cbranch_scc1 L_pg3
    s_branch L_pg4
L_pg_ret:
    s_mov_b64 exec, -1
    s_waitcnt vmcnt(11)
    ds_read_b128 v[96:99], v3 offset:0
    s_add_u32 m0, s8, 24576
    s_nop 0
    buffer_load_dwordx4 v1, s[48:51], s91 offen offset:0  lds
    buffer_load_dwordx4 v210, s[48:51], s91 offen offset:1024  lds
    s_waitcnt vmcnt(12)
    ds_read_b128 v[100:103], v3 offset:1024
    s_add_u32 m0, s6, 0
    s_nop 0
    buffer_load_dwordx4 v4, s[52:55], s88 offen offset:0  lds
    buffer_load_dwordx4 v5, s[52:55], s88 offen offset:1024  lds
    s_waitcnt lgkmcnt(1)
    v_dot2_f32_bf16 v152, v96, s9, 0
    v_dot2_f32_bf16 v156, v96, v96, 0
    v_dot2_f32_bf16 v153, v97, s9, 0
    v_dot2_f32_bf16 v157, v97, v97, 0
    v_dot2_f32_bf16 v152, v98, s9, v152
    v_dot2_f32_bf16 v156, v98, v98, v156
    v_dot2_f32_bf16 v153, v99, s9, v153
    v_dot2_f32_bf16 v157, v99, v99, v157
    s_waitcnt vmcnt(13)
    ds_read_b128 v[104:107], v3 offset:8192
    s_add_u32 m0, s6, 2048
    s_nop 0
    buffer_load_dwordx4 v4, s[56:59], s88 offen offset:0  lds
    buffer_load_dwordx4 v5, s[56:59], s88 offen offset:1024  lds
    s_waitcnt lgkmcnt(1)
    v_dot2_f32_bf16 v154, v100, s9, 0
    v_dot2_f32_bf16 v158, v100, v100, 0
    v_dot2_f32_bf16 v155, v101, s9, 0
    v_dot2_f32_bf16 v159, v101, v101, 0
    v_dot2_f32_bf16 v154, v102, s9, v154
    v_dot2_f32_bf16 v158, v102, v102, v158
    v_dot2_f32_bf16 v155, v103, s9, v155
    v_dot2_f32_bf16 v159, v103, v103, v159
    s_waitcnt vmcnt(14)
    ds_read_b128 v[108:111], v3 offset:9216
    s_add_u32 m0, s8, 32768
    s_nop 0
    buffer_load_dwordx4 v1, s[48:51], s92 offen offset:0  lds
    buffer_load_dwordx4 v210, s[48:51], s92 offen offset:1024  lds
    s_waitcnt lgkmcnt(1)
    v_dot2_f32_bf16 v152, v104, s9, v152
    v_dot2_f32_bf16 v156, v104, v104, v156
    v_dot2_f32_bf16 v153, v105, s9, v153
    v_dot2_f32_bf16 v157, v105, v105, v157
    v_dot2_f32_bf16 v152, v106, s9, v152
    v_dot2_f32_bf16 v156, v106, v106, v156
    v_dot2_f32_bf16 v153, v107, s9, v153
    v_dot2_f32_bf16 v157, v107, v107, v157
    s_waitcnt vmcnt(9)
    ds_read_b128 v[112:115], v3 offset:16384
    s_add_u32 m0, s6, 4096
    s_nop 0
    buffer_load_dwordx4 v4, s[52:55], s89 offen offset:0  lds
    buffer_load_dwordx4 v5, s[52:55], s89 offen offset:1024  lds
    s_waitcnt lgkmcnt(1)
    v_dot2_f32_bf16 v154, v108, s9, v154
    v_dot2_f32_bf16 v158, v108, v108, v158
    v_dot2_f32_bf16 v155, v109, s9, v155
    v_dot2_f32_bf16 v159, v109, v109, v159
    v_dot2_f32_bf16 v154, v110, s9, v154
    v_dot2_f32_bf16 v158, v110, v110, v158
    v_dot2_f32_bf16 v155, v111, s9, v155
    v_dot2_f32_bf16 v159, v111, v111, v159
    s_waitcnt vmcnt(10)
    ds_read_b128 v[116:119], v3 offset:17408
    s_add_u32 m0, s6, 6144
    s_nop 0
    buffer_load_dwordx4 v4, s[56:59], s89 offen offset:0  lds
    buffer_load_dwordx4 v5, s[56:59], s89 offen offset:1024  lds
    s_waitcnt lgkmcnt(1)
    v_dot2_f32_bf16 v152, v112, s9, v152
    v_dot2_f32_bf16 v156, v112, v112, v156
    v_dot2_f32_bf16 v153, v113, s9, v153
    v_dot2_f32_bf16 v157, v113, v113, v157
    v_dot2_f32_bf16 v152, v114, s9, v152
    v_dot2_f32_bf16 v156, v114, v114, v156
    v_dot2_f32_bf16 v153, v115, s9, v153
    v_dot2_f32_bf16 v157, v115, v115, v157
    s_waitcnt vmcnt(11)
    ds_read_b128 v[120:123], v3 offset:24576
    s_add_u32 m0, s8, 40960
    s_nop 0
    buffer_load_dwordx4 v1, s[48:51], s93 offen offset:0  lds
    buffer_load_dwordx4 v210, s[48:51], s93 offen offset:1024  lds
    s_waitcnt lgkmcnt(1)
    v_dot2_f32_bf16 v154, v116, s9, v154
    v_dot2_f32_bf16 v158, v116, v116, v158
    v_dot2_f32_bf16 v155, v117, s9, v155
    v_dot2_f32_bf16 v159, v117, v117, v159
    v_dot2_f32_bf16 v154, v118, s9, v154
    v_dot2_f32_bf16 v158, v118, v118, v158
    v_dot2_f32_bf16 v155, v119, s9, v155
    v_dot2_f32_bf16 v159, v119, v119, v159
    s_waitcnt vmcnt(12)
    ds_read_b128 v[124:127], v3 offset:25600
    s_add_u32 m0, s6, 8192
    s_nop 0
    buffer_load_dwordx4 v4, s[52:55], s90 offen offset:0  lds
    buffer_load_dwordx4 v5, s[52:55], s90 offen offset:1024  lds
    s_waitcnt lgkmcnt(1)
    v_dot2_f32_bf16 v152, v120, s9, v152
    v_dot2_f32_bf16 v156, v120, v120, v156
    v_dot2_f32_bf16 v153, v121, s9, v153
    v_dot2_f32_bf16 v157, v121, v121, v157
    v_dot2_f32_bf16 v152, v122, s9, v152
    v_dot2_f32_bf16 v156, v122, v122, v156
    v_dot2_f32_bf16 v153, v123, s9, v153
    v_dot2_f32_bf16 v157, v123, v123, v157
    s_barrier
    ds_read_b128 a[0:3], v22 offset:0
    ds_read_b128 a[4:7], v23 offset:0
    ds_read_b128 a[8:11], v22 offset:2048
    ds_read_b128 a[12:15], v23 offset:2048
    s_waitcnt vmcnt(12)
    ds_read_b128 a[224:227], v16 offset:0
    ds_read_b128 a[228:231], v17 offset:0
    ds_read_b128 a[16:19], v22 offset:4096
    ds_read_b128 a[20:23], v23 offset:4096
    ds_read_b128 a[24:27], v22 offset:6144
    ds_read_b128 a[28:31], v23 offset:6144
    s_waitcnt vmcnt(10)
    ds_read_b128 a[232:235], v16 offset:2048
    ds_read_b128 a[236:239], v17 offset:2048
    s_waitcnt lgkmcnt(6)
    v_dot2_f32_bf16 v154, v124, s9, v154
    v_dot2_f32_bf16 v158, v124, v124, v158
    v_dot2_f32_bf16 v155, v125, s9, v155
    v_dot2_f32_bf16 v159, v125, v125, v159
    v_dot2_f32_bf16 v154, v126, s9, v154
    v_dot2_f32_bf16 v158, v126, v126, v158
    v_dot2_f32_bf16 v155, v127, s9, v155
    v_dot2_f32_bf16 v159, v127, v127, v159
    s_waitcnt vmcnt(6) lgkmcnt(2)
    v_mfma_f32_16x16x32_bf16 v[64:67], a[0:3], a[224:227], 0
    ds_read_b128 a[32:35], v22 offset:8192
    ds_read_b128 a[36:39], v23 offset:8192
    v_mfma_f32_16x16x32_bf16 v[64:67], a[4:7], a[228:231], v[64:67]
    s_add_u32 m0, s6, 10240
    s_nop 0
    buffer_load_dwordx4 v4, s[56:59], s90 offen offset:0  lds
    v_mfma_f32_16x16x32_bf16 v[68:71], a[8:11], a[224:227], 0
    ds_read_b128 a[40:43], v22 offset:10240
    ds_read_b128 a[44:47], v23 offset:10240
    v_mfma_f32_16x16x32_bf16 v[68:71], a[12:15], a[228:231], v[68:71]
    buffer_load_dwordx4 v5, s[56:59], s90 offen offset:1024  lds
    v_mfma_f32_16x16x32_bf16 v[72:75], a[16:19], a[224:227], 0
    ds_read_b128 a[240:243], v16 offset:4096
    ds_read_b128 a[244:247], v17 offset:4096
    v_mfma_f32_16x16x32_bf16 v[72:75], a[20:23], a[228:231], v[72:75]
    s_add_u32 m0, s8, 49152
    v_lshlrev_b32 v250, 16, v250
    v_lshlrev_b32 v248, 16, v248
    v_mul_f32 v250, s10, v250
    v_lshlrev_b32 v249, 16, v249
    v_mfma_f32_16x16x32_bf16 v[76:79], a[24:27], a[224:227], 0
    buffer_load_dwordx4 v1, s[48:51], s94 offen offset:0  lds
    v_mfma_f32_16x16x32_bf16 v[76:79], a[28:31], a[228:231], v[76:79]
    buffer_load_dwordx4 v210, s[48:51], s94 offen offset:1024  lds
    v_smfmac_f32_16x16x64_bf16 v[180:183], v[176:179], a[224:231], v209
    s_waitcnt vmcnt(8) lgkmcnt(6)
    v_mfma_f32_16x16x32_bf16 v[80:83], a[0:3], a[232:235], 0
    ds_read_b128 a[48:51], v22 offset:12288
    ds_read_b128 a[52:55], v23 offset:12288
    v_mfma_f32_16x16x32_bf16 v[80:83], a[4:7], a[236:239], v[80:83]
    s_add_u32 m0, s6, 12288
    s_nop 0
    buffer_load_dwordx4 v4, s[52:55], s91 offen offset:0  lds
    v_mfma_f32_16x16x32_bf16 v[84:87], a[8:11], a[232:235], 0
    ds_read_b128 a[56:59], v22 offset:14336
    ds_read_b128 a[60:63], v23 offset:14336
    v_mfma_f32_16x16x32_bf16 v[84:87], a[12:15], a[236:239], v[84:87]
    buffer_load_dwordx4 v5, s[52:55], s91 offen offset:1024  lds
    v_mfma_f32_16x16x32_bf16 v[88:91], a[16:19], a[232:235], 0
    ds_read_b128 a[248:251], v16 offset:6144
    ds_read_b128 a[252:255], v17 offset:6144
    v_mfma_f32_16x16x32_bf16 v[88:91], a[20:23], a[236:239], v[88:91]
    s_add_u32 m0, s6, 14336
    s_nop 0
    buffer_load_dwordx4 v4, s[56:59], s91 offen offset:0  lds
    v_mfma_f32_16x16x32_bf16 v[92:95], a[24:27], a[232:235], 0
    buffer_load_dwordx4 v5, s[56:59], s91 offen offset:1024  lds
    v_mfma_f32_16x16x32_bf16 v[92:95], a[28:31], a[236:239], v[92:95]
    ds_read_b128 v[128:131], v3 offset:32768
    ds_read_b128 v[132:135], v3 offset:33792
    v_smfmac_f32_16x16x64_bf16 v[184:187], v[176:179], a[232:239], v209
    s_waitcnt lgkmcnt(1)
    v_dot2_f32_bf16 v152, v128, s9, v152
    v_dot2_f32_bf16 v156, v128, v128, v156
    v_dot2_f32_bf16 v153, v129, s9, v153
    v_dot2_f32_bf16 v157, v129, v129, v157
    v_dot2_f32_bf16 v152, v130, s9, v152
    v_dot2_f32_bf16 v156, v130, v130, v156
    v_dot2_f32_bf16 v153, v131, s9, v153
    v_dot2_f32_bf16 v157, v131, v131, v157
L_pg1:
    s_cbranch_execz L_pg5
    s_waitcnt lgkmcnt(0)
    v_dot2_f32_bf16 v154, v132, s9, v154
    v_dot2_f32_bf16 v158, v132, v132, v158
    v_dot2_f32_bf16 v155, v133, s9, v155
    v_dot2_f32_bf16 v159, v133, v133, v159
    v_dot2_f32_bf16 v154, v134, s9, v154
    v_dot2_f32_bf16 v158, v134, v134, v158
    v_dot2_f32_bf16 v155, v135, s9, v155
    v_dot2_f32_bf16 v159, v135, v135, v159
    s_waitcnt vmcnt(8)
    v_mfma_f32_16x16x32_bf16 v[64:67], a[32:35], a[240:243], v[64:67]
    ds_read_b128 a[64:67], v22 offset:16384
    ds_read_b128 a[68:71], v23 offset:16384
    v_mfma_f32_16x16x32_bf16 v[64:67], a[36:39], a[244:247], v[64:67]
    s_add_u32 m0, s6, 16384
    s_nop 0
    buffer_load_dwordx4 v4, s[52:55], s92 offen offset:0  lds
    v_mfma_f32_16x16x32_bf16 v[68:71], a[40:43], a[240:243], v[68:71]
    ds_read_b128 a[72:75], v22 offset:18432
    ds_read_b128 a[76:79], v23 offset:18432
    v_mfma_f32_16x16x32_bf16 v[68:71], a[44:47], a[244:247], v[68:71]
    buffer_load_dwordx4 v5, s[52:55], s92 offen offset:1024  lds
    v_mfma_f32_16x16x32_bf16 v[72:75], a[48:51], a[240:243], v[72:75]
    ds_read_b128 a[224:227], v16 offset:8192
    ds_read_b128 a[228:231], v17 offset:8192
    v_mfma_f32_16x16x32_bf16 v[72:75], a[52:55], a[244:247], v[72:75]
    s_add_u32 m0, s6, 18432
    v_exp_f32 v250, v250
    v_lshlrev_b32 v208, 16, v208
    v_mul_f32 v46, v248, v248
    v_cvt_pk_bf16_f32 v250, v250, v250
    v_mfma_f32_16x16x32_bf16 v[76:79], a[56:59], a[240:243], v[76:79]
    buffer_load_dwordx4 v4, s[56:59], s92 offen offset:0  lds
    v_mfma_f32_16x16x32_bf16 v[76:79], a[60:63], a[244:247], v[76:79]
    ds_read_b128 v[136:139], v3 offset:40960
    ds_read_b128 v[140:143], v3 offset:41984
    v_smfmac_f32_16x16x64_bf16 v[180:183], v[176:179], a[240:247], v209
    s_waitcnt lgkmcnt(1)
    v_dot2_f32_bf16 v152, v136, s9, v152
    v_dot2_f32_bf16 v156, v136, v136, v156
    v_dot2_f32_bf16 v153, v137, s9, v153
    v_dot2_f32_bf16 v157, v137, v137, v157
    v_dot2_f32_bf16 v152, v138, s9, v152
    v_dot2_f32_bf16 v156, v138, v138, v156
    v_dot2_f32_bf16 v153, v139, s9, v153
    v_dot2_f32_bf16 v157, v139, v139, v157
    s_waitcnt lgkmcnt(0)
    v_dot2_f32_bf16 v154, v140, s9, v154
    v_dot2_f32_bf16 v158, v140, v140, v158
    v_dot2_f32_bf16 v155, v141, s9, v155
    v_dot2_f32_bf16 v159, v141, v141, v159
    v_dot2_f32_bf16 v154, v142, s9, v154
    v_dot2_f32_bf16 v158, v142, v142, v158
    v_dot2_f32_bf16 v155, v143, s9, v155
    v_dot2_f32_bf16 v159, v143, v143, v159
    s_waitcnt vmcnt(9)
    v_mfma_f32_16x16x32_bf16 v[80:83], a[32:35], a[248:251], v[80:83]
    ds_read_b128 a[80:83], v22 offset:20480
    ds_read_b128 a[84:87], v23 offset:20480
    v_mfma_f32_16x16x32_bf16 v[80:83], a[36:39], a[252:255], v[80:83]
    buffer_load_dwordx4 v5, s[56:59], s92 offen offset:1024  lds
    v_mfma_f32_16x16x32_bf16 v[84:87], a[40:43], a[248:251], v[84:87]
    ds_read_b128 a[88:91], v22 offset:22528
    ds_read_b128 a[92:95], v23 offset:22528
    v_mfma_f32_16x16x32_bf16 v[84:87], a[44:47], a[252:255], v[84:87]
    s_add_u32 m0, s6, 20480
    v_and_b32 v250, 0xffff0000, v250
    v_fmac_f32 v46, v249, v249
    v_mul_f32 v251, v250, v248
    v_mfma_f32_16x16x32_bf16 v[88:91], a[48:51], a[248:251], v[88:91]
    ds_read_b128 a[232:235], v16 offset:10240
    ds_read_b128 a[236:239], v17 offset:10240
    v_mfma_f32_16x16x32_bf16 v[88:91], a[52:55], a[252:255], v[88:91]
    buffer_load_dwordx4 v4, s[52:55], s93 offen offset:0  lds
    v_mfma_f32_16x16x32_bf16 v[92:95], a[56:59], a[248:251], v[92:95]
    buffer_load_dwordx4 v5, s[52:55], s93 offen offset:1024  lds
    v_mfma_f32_16x16x32_bf16 v[92:95], a[60:63], a[252:255], v[92:95]
    v_mul_f32 v252, v250, v249
    v_mul_f32 v251, s10, v251
    v_mul_f32 v252, 0.15915494, v252
    v_smfmac_f32_16x16x64_bf16 v[184:187], v[176:179], a[248:255], v209
    s_waitcnt vmcnt(8) lgkmcnt(2)
    v_mfma_f32_16x16x32_bf16 v[64:67], a[64:67], a[224:227], v[64:67]
    ds_read_b128 a[96:99], v22 offset:24576
    ds_read_b128 a[100:103], v23 offset:24576
    v_mfma_f32_16x16x32_bf16 v[64:67], a[68:71], a[228:231], v[64:67]
    s_add_u32 m0, s6, 22528
    v_exp_f32 v251, v251
    v_rndne_f32 v250, v252
    v_mfma_f32_16x16x32_bf16 v[68:71], a[72:75], a[224:227], v[68:71]
    ds_read_b128 a[104:107], v22 offset:26624
    ds_read_b128 a[108:111], v23 offset:26624
    v_mfma_f32_16x16x32_bf16 v[68:71], a[76:79], a[228:231], v[68:71]
    buffer_load_dwordx4 v4, s[56:59], s93 offen offset:0  lds
    v_mfma_f32_16x16x32_bf16 v[72:75], a[80:83], a[224:227], v[72:75]
    ds_read_b128 a[240:243], v16 offset:12288
    ds_read_b128 a[244:247], v17 offset:12288
    v_mfma_f32_16x16x32_bf16 v[72:75], a[84:87], a[228:231], v[72:75]
    buffer_load_dwordx4 v5, s[56:59], s93 offen offset:1024  lds
    v_mfma_f32_16x16x32_bf16 v[76:79], a[88:91], a[224:227], v[76:79]
    ds_read_b128 v[144:147], v3 offset:49152
    ds_read_b128 v[148:151], v3 offset:50176
    v_mfma_f32_16x16x32_bf16 v[76:79], a[92:95], a[228:231], v[76:79]
    v_sub_f32 v252, v252, v250
    v_cos_f32 v44, v252
    v_smfmac_f32_16x16x64_bf16 v[180:183], v[176:179], a[224:231], v209
    s_barrier
    s_waitcnt lgkmcnt(1)
    v_dot2_f32_bf16 v152, v144, s9, v152
    v_dot2_f32_bf16 v156, v144, v144, v156
    v_dot2_f32_bf16 v153, v145, s9, v153
    v_dot2_f32_bf16 v157, v145, v145, v157
    v_dot2_f32_bf16 v152, v146, s9, v152
    v_dot2_f32_bf16 v156, v146, v146, v156
    v_dot2_f32_bf16 v153, v147, s9, v153
    v_dot2_f32_bf16 v157, v147, v147, v157
    s_waitcnt lgkmcnt(0)
    v_dot2_f32_bf16 v154, v148, s9, v154
    v_dot2_f32_bf16 v158, v148, v148, v158
    v_dot2_f32_bf16 v155, v149, s9, v155
    v_dot2_f32_bf16 v159, v149, v149, v159
    v_dot2_f32_bf16 v154, v150, s9, v154
    v_dot2_f32_bf16 v158, v150, v150, v158
    v_dot2_f32_bf16 v155, v151, s9, v155
    v_dot2_f32_bf16 v159, v151, v151, v159
    s_waitcnt vmcnt(8)
    v_mfma_f32_16x16x32_bf16 v[80:83], a[64:67], a[232:235], v[80:83]
    ds_read_b128 a[112:115], v22 offset:28672
    ds_read_b128 a[116:119], v23 offset:28672
    v_mfma_f32_16x16x32_bf16 v[80:83], a[68:71], a[236:239], v[80:83]
    s_add_u32 m0, s6, 0
    v_add_f32 v152, v152, v153
    v_add_f32 v156, v156, v157
    v_add_f32 v154, v154, v155
    v_add_f32 v158, v158, v159
    v_add_f32_dpp v152, v152, v152 quad_perm:[1,0,3,2] row_mask:0xf bank_mask:0xf
    v_mfma_f32_16x16x32_bf16 v[84:87], a[72:75], a[232:235], v[84:87]
    ds_read_b128 a[120:123], v22 offset:30720
    ds_read_b128 a[124:127], v23 offset:30720
    v_mfma_f32_16x16x32_bf16 v[84:87], a[76:79], a[236:239], v[84:87]
    buffer_load_dwordx4 v4, s[52:55], s94 offen offset:0  lds
    v_mfma_f32_16x16x32_bf16 v[88:91], a[80:83], a[232:235], v[88:91]
    ds_read_b128 a[248:251], v16 offset:14336
    ds_read_b128 a[252:255], v17 offset:14336
    v_mfma_f32_16x16x32_bf16 v[88:91], a[84:87], a[236:239], v[88:91]
    buffer_load_dwordx4 v5, s[52:55], s94 offen offset:1024  lds
    v_mfma_f32_16x16x32_bf16 v[92:95], a[88:91], a[232:235], v[92:95]
    s_add_u32 m0, s6, 2048
    v_add_f32_dpp v156, v156, v156 quad_perm:[1,0,3,2] row_mask:0xf bank_mask:0xf
    v_add_f32_dpp v154, v154, v154 quad_perm:[1,0,3,2] row_mask:0xf bank_mask:0xf
    v_add_f32_dpp v158, v158, v158 quad_perm:[1,0,3,2] row_mask:0xf bank_mask:0xf
    v_add_f32_dpp v152, v152, v152 quad_perm:[2,3,0,1] row_mask:0xf bank_mask:0xf
    v_add_f32_dpp v156, v156, v156 quad_perm:[2,3,0,1] row_mask:0xf bank_mask:0xf
    v_mfma_f32_16x16x32_bf16 v[92:95], a[92:95], a[236:239], v[92:95]
    buffer_load_dwordx4 v4, s[56:59], s94 offen offset:0  lds
    v_smfmac_f32_16x16x64_bf16 v[184:187], v[176:179], a[232:239], v209
    s_waitcnt vmcnt(9) lgkmcnt(2)
    v_mfma_f32_16x16x32_bf16 v[64:67], a[96:99], a[240:243], v[64:67]
    ds_read_b128 a[128:131], v22 offset:32768
    ds_read_b128 a[132:135], v23 offset:32768
    v_mfma_f32_16x16x32_bf16 v[64:67], a[100:103], a[244:247], v[64:67]
    buffer_load_dwordx4 v5, s[56:59], s94 offen offset:1024  lds
    v_mfma_f32_16x16x32_bf16 v[68:71], a[104:107], a[240:243], v[68:71]
    ds_read_b128 a[136:139], v22 offset:34816
    ds_read_b128 a[140:143], v23 offset:34816
    v_mfma_f32_16x16x32_bf16 v[68:71], a[108:111], a[244:247], v[68:71]
    s_add_u32 m0, s6, 4096
    s_mul_i32 s88, s88, 1792
    v_add_f32_dpp v154, v154, v154 quad_perm:[2,3,0,1] row_mask:0xf bank_mask:0xf
    v_add_f32_dpp v158, v158, v158 quad_perm:[2,3,0,1] row_mask:0xf bank_mask:0xf
    v_add_f32_dpp v160, v152, v152 row_half_mirror row_mask:0xf bank_mask:5
    v_add_f32_dpp v161, v156, v156 row_half_mirror row_mask:0xf bank_mask:5
    v_mfma_f32_16x16x32_bf16 v[72:75], a[112:115], a[240:243], v[72:75]
    ds_read_b128 a[224:227], v16 offset:16384
    ds_read_b128 a[228:231], v17 offset:16384
    v_mfma_f32_16x16x32_bf16 v[72:75], a[116:119], a[244:247], v[72:75]
    buffer_load_dwordx4 v8, s[68:71], s88 offen offset:0  lds
    v_mfma_f32_16x16x32_bf16 v[76:79], a[120:123], a[240:243], v[76:79]
    buffer_load_dwordx4 v9, s[68:71], s88 offen offset:1024  lds
    v_mfma_f32_16x16x32_bf16 v[76:79], a[124:127], a[244:247], v[76:79]
    s_mov_b32 vcc_lo, 0xaaaaaaaa
    v_add_f32_dpp v160, v154, v154 row_half_mirror row_mask:0xf bank_mask:10
    v_add_f32_dpp v161, v158, v158 row_half_mirror row_mask:0xf bank_mask:10
    s_mov_b32 vcc_hi, 0xaaaaaaaa
    v_mul_f32 v160, 0xbb124925, v160
    v_mul_f32 v161, 0x3b124925, v161
    v_smfmac_f32_16x16x64_bf16 v[180:183], v[176:179], a[240:247], v209
    s_waitcnt vmcnt(10) lgkmcnt(6)
    v_mfma_f32_16x16x32_bf16 v[80:83], a[96:99], a[248:251], v[80:83]
    ds_read_b128 a[144:147], v22 offset:36864
    ds_read_b128 a[148:151], v23 offset:36864
    v_mfma_f32_16x16x32_bf16 v[80:83], a[100:103], a[252:255], v[80:83]
    buffer_load_dwordx4 v10, s[68:71], s88 offen offset:2048  lds
    v_mfma_f32_16x16x32_bf16 v[84:87], a[104:107], a[248:251], v[84:87]
    ds_read_b128 a[152:155], v22 offset:38912
    ds_read_b128 a[156:159], v23 offset:38912
    v_mfma_f32_16x16x32_bf16 v[84:87], a[108:111], a[252:255], v[84:87]
    buffer_load_dwordx4 v11, s[68:71], s88 offen offset:3072  lds
    v_mfma_f32_16x16x32_bf16 v[88:91], a[112:115], a[248:251], v[88:91]
    ds_read_b128 a[232:235], v16 offset:18432
    ds_read_b128 a[236:239], v17 offset:18432
    v_mfma_f32_16x16x32_bf16 v[88:91], a[116:119], a[252:255], v[88:91]
    s_add_u32 m0, s6, 8192
    s_mul_i32 s89, s89, 1792
    v_fma_f32 v161, -v160, v160, v161
    v_cvt_pk_bf16_f32 v164, v160, v160
    v_max_f32 v161, 0, v161
    v_and_b32 v162, 0xffff0000, v164
    v_mfma_f32_16x16x32_bf16 v[92:95], a[120:123], a[248:251], v[92:95]
    buffer_load_dwordx4 v8, s[68:71], s89 offen offset:0  lds
    v_mfma_f32_16x16x32_bf16 v[92:95], a[124:127], a[252:255], v[92:95]
    v_cvt_pk_bf16_f32 v161, v161, v161
    v_and_b32 v161, 0xffff0000, v161
    v_add_f32 v161, 0x3727c5ac, v161
    v_cvt_pk_bf16_f32 v161, v161, v161
    v_and_b32 v161, 0xffff0000, v161
    v_smfmac_f32_16x16x64_bf16 v[184:187], v[176:179], a[248:255], v209
    s_waitcnt vmcnt(11) lgkmcnt(2)
    v_mfma_f32_16x16x32_bf16 v[64:67], a[128:131], a[224:227], v[64:67]
    ds_read_b128 a[160:163], v22 offset:40960
    ds_read_b128 a[164:167], v23 offset:40960
    v_mfma_f32_16x16x32_bf16 v[64:67], a[132:135], a[228:231], v[64:67]
    buffer_load_dwordx4 v9, s[68:71], s89 offen offset:1024  lds
    v_mfma_f32_16x16x32_bf16 v[68:71], a[136:139], a[224:227], v[68:71]
    ds_read_b128 a[168:171], v22 offset:43008
    ds_read_b128 a[172:175], v23 offset:43008
    v_mfma_f32_16x16x32_bf16 v[68:71], a[140:143], a[228:231], v[68:71]
    buffer_load_dwordx4 v10, s[68:71], s89 offen offset:2048  lds
    v_mfma_f32_16x16x32_bf16 v[72:75], a[144:147], a[224:227], v[72:75]
    ds_read_b128 a[240:243], v16 offset:20480
    ds_read_b128 a[244:247], v17 offset:20480
    v_mfma_f32_16x16x32_bf16 v[72:75], a[148:151], a[228:231], v[72:75]
    v_sqrt_f32 v161, v161
    s_mov_b32 s14, 0xcccccccc
    v_cvt_pk_bf16_f32 v163, v160, v161
    s_mov_b32 s15, s14
    v_mfma_f32_16x16x32_bf16 v[76:79], a[152:155], a[224:227], v[76:79]
    v_and_b32 v161, 0xffff0000, v163
    v_rcp_f32 v161, v161
    v_cndmask_b32 v164, v164, v163, vcc
    v_cndmask_b32 v162, v162, v161, vcc
    v_mfma_f32_16x16x32_bf16 v[76:79], a[156:159], a[228:231], v[76:79]
    v_cndmask_b32 v162, v162, v164, s[14:15]
    v_smfmac_f32_16x16x64_bf16 v[180:183], v[176:179], a[224:231], v209
    ds_write_b32 v2, v162 offset:57344
    s_waitcnt lgkmcnt(0)
    s_barrier
    s_waitcnt vmcnt(11)
    v_mfma_f32_16x16x32_bf16 v[80:83], a[128:131], a[232:235], v[80:83]
    ds_read_b128 a[176:179], v22 offset:45056
    ds_read_b128 a[180:183], v23 offset:45056
    v_mfma_f32_16x16x32_bf16 v[80:83], a[132:135], a[236:239], v[80:83]
    buffer_load_dwordx4 v11, s[68:71], s89 offen offset:3072  lds
    v_mfma_f32_16x16x32_bf16 v[84:87], a[136:139], a[232:235], v[84:87]
    ds_read_b128 a[184:187], v22 offset:47104
    ds_read_b128 a[188:191], v23 offset:47104
    v_mfma_f32_16x16x32_bf16 v[84:87], a[140:143], a[236:239], v[84:87]
    s_add_u32 m0, s6, 12288
    s_mul_i32 s90, s90, 1792
    ds_read2_b64 v[196:199], v240 offset0:0 offset1:4
    ds_read2_b64 v[200:203], v240 offset0:8 offset1:12
    ds_read2_b32 v[60:61], v241 offset0:0 offset1:4
    ds_read2_b32 v[62:63], v241 offset0:8 offset1:12
    ds_read_b128 v[128:131], v242 offset:57600
    ds_read_b128 v[132:135], v242 offset:57616
    v_mfma_f32_16x16x32_bf16 v[88:91], a[144:147], a[232:235], v[88:91]
    ds_read_b128 a[248:251], v16 offset:22528
    ds_read_b128 a[252:255], v17 offset:22528
    v_mfma_f32_16x16x32_bf16 v[88:91], a[148:151], a[236:239], v[88:91]
    buffer_load_dwordx4 v8, s[68:71], s90 offen offset:0  lds
    v_mfma_f32_16x16x32_bf16 v[92:95], a[152:155], a[232:235], v[92:95]
    buffer_load_dwordx4 v9, s[68:71], s90 offen offset:1024  lds
    v_mfma_f32_16x16x32_bf16 v[92:95], a[156:159], a[236:239], v[92:95]
    ds_read_b128 v[136:139], v242 offset:57632
    ds_read_b128 v[140:143], v242 offset:57648
    ds_read_u16 v160, v244 offset:0
    ds_read_u16 v161, v244 offset:128
    ds_read_u16 v162, v245 offset:256
    ds_read_u16 v163, v245 offset:384
    ds_read_u16 v164, v246 offset:0
    ds_read_u16 v165, v246 offset:128
    v_smfmac_f32_16x16x64_bf16 v[184:187], v[176:179], a[232:239], v209
    s_waitcnt vmcnt(12) lgkmcnt(6)
    v_mfma_f32_16x16x32_bf16 v[64:67], a[160:163], a[240:243], v[64:67]
    ds_read_b128 a[192:195], v22 offset:49152
    ds_read_b128 a[196:199], v23 offset:49152
    v_mfma_f32_16x16x32_bf16 v[64:67], a[164:167], a[244:247], v[64:67]
    buffer_load_dwordx4 v10, s[68:71], s90 offen offset:2048  lds
    v_mfma_f32_16x16x32_bf16 v[68:71], a[168:171], a[240:243], v[68:71]
    ds_read_b128 a[200:203], v22 offset:51200
    ds_read_b128 a[204:207], v23 offset:51200
    v_mfma_f32_16x16x32_bf16 v[68:71], a[172:175], a[244:247], v[68:71]
    buffer_load_dwordx4 v11, s[68:71], s90 offen offset:3072  lds
    v_mfma_f32_16x16x32_bf16 v[72:75], a[176:179], a[240:243], v[72:75]
    ds_read_b128 a[224:227], v16 offset:0
    ds_read_b128 a[228:231], v17 offset:0
    v_mfma_f32_16x16x32_bf16 v[72:75], a[180:183], a[244:247], v[72:75]
    s_add_u32 m0, s6, 16384
    s_mul_i32 s91, s91, 1792
    ds_read_u16 v166, v247 offset:256
    ds_read_u16 v167, v247 offset:384
    ds_read_u16 v168, v244 offset:2048
    ds_read_u16 v169, v244 offset:2176
    ds_read_u16 v170, v245 offset:2304
    ds_read_u16 v171, v245 offset:2432
    v_mfma_f32_16x16x32_bf16 v[76:79], a[184:187], a[240:243], v[76:79]
    buffer_load_dwordx4 v8, s[68:71], s91 offen offset:0  lds
    v_mfma_f32_16x16x32_bf16 v[76:79], a[188:191], a[244:247], v[76:79]
    ds_read_u16 v172, v246 offset:2048
    ds_read_u16 v173, v246 offset:2176
    ds_read_u16 v174, v247 offset:2304
    ds_read_u16 v175, v247 offset:2432
    v_and_b32 v196, v253, v196
    v_and_b32 v197, v254, v197
    v_and_b32 v198, v253, v198
    v_and_b32 v199, v254, v199
    v_smfmac_f32_16x16x64_bf16 v[180:183], v[176:179], a[240:247], v209
    s_waitcnt vmcnt(13)
    v_mfma_f32_16x16x32_bf16 v[80:83], a[160:163], a[248:251], v[80:83]
    ds_read_b128 a[208:211], v22 offset:53248
    ds_read_b128 a[212:215], v23 offset:53248
    v_mfma_f32_16x16x32_bf16 v[80:83], a[164:167], a[252:255], v[80:83]
    buffer_load_dwordx4 v9, s[68:71], s91 offen offset:1024  lds
    v_mfma_f32_16x16x32_bf16 v[84:87], a[168:171], a[248:251], v[84:87]
    ds_read_b128 a[216:219], v22 offset:55296
    ds_read_b128 a[220:223], v23 offset:55296
    v_mfma_f32_16x16x32_bf16 v[84:87], a[172:175], a[252:255], v[84:87]
    buffer_load_dwordx4 v10, s[68:71], s91 offen offset:2048  lds
    v_mfma_f32_16x16x32_bf16 v[88:91], a[176:179], a[248:251], v[88:91]
    ds_read_b128 a[232:235], v16 offset:2048
    ds_read_b128 a[236:239], v17 offset:2048
    v_mfma_f32_16x16x32_bf16 v[88:91], a[180:183], a[252:255], v[88:91]
    buffer_load_dwordx4 v11, s[68:71], s91 offen offset:3072  lds
    v_mfma_f32_16x16x32_bf16 v[92:95], a[184:187], a[248:251], v[92:95]
    s_load_dword s46, s[44:45], 0
    v_and_b32 v200, v253, v200
    v_and_b32 v201, v254, v201
    v_and_b32 v202, v253, v202
    v_and_b32 v203, v254, v203
    v_mul_f32 v60, s10, v60
    v_mul_f32 v61, s10, v61
    v_mul_f32 v62, s10, v62
    v_mfma_f32_16x16x32_bf16 v[92:95], a[188:191], a[252:255], v[92:95]
    v_mul_f32 v63, s10, v63
    v_sin_f32 v45, v252
    v_rcp_f32 v250, v46
    v_mul_f32 v44, v44, v251
    v_mul_f32 v45, v45, v251
    v_mul_f32 v250, 0x4038aa3b, v250
    v_smfmac_f32_16x16x64_bf16 v[184:187], v[176:179], a[248:255], v209
    s_waitcnt vmcnt(12) lgkmcnt(2)
    v_mfma_f32_16x16x32_bf16 v[64:67], a[192:195], a[224:227], v[64:67]
    ds_read_b64_tr_b16 a[240:241], v18 offset:4096
    ds_read_b64_tr_b16 a[242:243], v18 offset:4352
    v_mfma_f32_16x16x32_bf16 v[64:67], a[196:199], a[228:231], v[64:67]
    s_add_u32 m0, s6, 20480
    s_mul_i32 s92, s92, 1792
    v_subrev_f32 v251, 1.0, v44
    v_mul_f32 v46, v45, v249
    v_mul_f32 v47, v45, v248
    v_mfma_f32_16x16x32_bf16 v[68:71], a[200:203], a[224:227], v[68:71]
    ds_read_b64_tr_b16 a[244:245], v18 offset:6144
    ds_read_b64_tr_b16 a[246:247], v18 offset:6400
    v_mfma_f32_16x16x32_bf16 v[68:71], a[204:207], a[228:231], v[68:71]
    buffer_load_dwordx4 v8, s[68:71], s92 offen offset:0  lds
    v_mfma_f32_16x16x32_bf16 v[72:75], a[208:211], a[224:227], v[72:75]
    buffer_load_dwordx4 v9, s[68:71], s92 offen offset:1024  lds
    v_mfma_f32_16x16x32_bf16 v[72:75], a[212:215], a[228:231], v[72:75]
    v_fmac_f32 v46, v251, v248
    v_fma_f32 v47, -v251, v249, v47
    v_mul_f32 v46, v46, v250
    v_mul_f32 v47, v47, v250
    v_mul_f32 v250, v45, v45
    v_mfma_f32_16x16x32_bf16 v[76:79], a[216:219], a[224:227], v[76:79]
    v_add_f32 v251, v44, v44
    v_fma_f32 v250, v44, v44, -v250
    v_mul_f32 v251, v251, v45
    v_mul_f32 v248, v251, v251
    v_add_f32 v249, v250, v250
    v_mfma_f32_16x16x32_bf16 v[76:79], a[220:223], a[228:231], v[76:79]
    v_fma_f32 v248, v250, v250, -v248
    v_mul_f32 v249, v249, v251
    v_mul_f32 v48, v249, v249
    v_add_f32 v49, v248, v248
    v_fma_f32 v48, v248, v248, -v48
    v_smfmac_f32_16x16x64_bf16 v[180:183], v[176:179], a[224:231], v209
    s_waitcnt lgkmcnt(4)
    v_mfma_f32_16x16x32_bf16 v[80:83], a[192:195], a[232:235], v[80:83]
    ds_read_b64_tr_b16 a[248:249], v19 offset:4096
    ds_read_b64_tr_b16 a[250:251], v19 offset:4352
    v_mfma_f32_16x16x32_bf16 v[80:83], a[196:199], a[236:239], v[80:83]
    buffer_load_dwordx4 v10, s[68:71], s92 offen offset:2048  lds
    v_mfma_f32_16x16x32_bf16 v[84:87], a[200:203], a[232:235], v[84:87]
    ds_read_b64_tr_b16 a[252:253], v19 offset:6144
    ds_read_b64_tr_b16 a[254:255], v19 offset:6400
    v_mfma_f32_16x16x32_bf16 v[84:87], a[204:207], a[236:239], v[84:87]
    buffer_load_dwordx4 v11, s[68:71], s92 offen offset:3072  lds
    v_mfma_f32_16x16x32_bf16 v[88:91], a[208:211], a[232:235], v[88:91]
    s_add_u32 m0, s6, 0
    s_mul_i32 s93, s93, 1792
    v_mul_f32 v49, v49, v249
    v_mul_f32 v50, v49, v49
    v_add_f32 v51, v48, v48
    v_fma_f32 v50, v48, v48, -v50
    v_mfma_f32_16x16x32_bf16 v[88:91], a[212:215], a[236:239], v[88:91]
    buffer_load_dwordx4 v8, s[68:71], s93 offen offset:0  lds
    v_mfma_f32_16x16x32_bf16 v[92:95], a[216:219], a[232:235], v[92:95]
    v_mul_f32 v51, v51, v49
    v_mul_f32 v52, v51, v51
    v_add_f32 v53, v50, v50
    v_fma_f32 v52, v50, v50, -v52
    v_mul_f32 v53, v53, v51
    v_mul_f32 v54, v53, v53
    v_mfma_f32_16x16x32_bf16 v[92:95], a[220:223], a[236:239], v[92:95]
    v_add_f32 v55, v52, v52
    v_fma_f32 v54, v52, v52, -v54
    v_mul_f32 v55, v55, v53
    v_mul_f32 v250, v55, v55
    v_add_f32 v251, v54, v54
    v_fma_f32 v250, v54, v54, -v250
    v_smfmac_f32_16x16x64_bf16 v[184:187], v[176:179], a[232:239], v209
    v_mul_f32 v251, v251, v55
    v_mul_f32 v248, v251, v251
    v_add_f32 v249, v250, v250
    v_fma_f32 v248, v250, v250, -v248
    v_mul_f32 v249, v249, v251
    v_mul_f32 v56, v249, v249
    v_add_f32 v57, v248, v248
    v_fma_f32 v56, v248, v248, -v56
    v_mul_f32 v57, v57, v249
    v_mul_f32 v58, v57, v57
    v_add_f32 v59, v56, v56
    v_fma_f32 v58, v56, v56, -v58
    v_mul_f32 v59, v59, v57
    s_waitcnt vmcnt(13) lgkmcnt(4)
    v_mfma_f32_16x16x32_bf16 v[96:99], a[240:243], a[0:3], 0
    ds_read_b64_tr_b16 a[224:225], v18 offset:8192
    ds_read_b64_tr_b16 a[226:227], v18 offset:8448
    v_mfma_f32_16x16x32_bf16 v[96:99], a[244:247], a[4:7], v[96:99]
    buffer_load_dwordx4 v9, s[68:71], s93 offen offset:1024  lds
    v_mfma_f32_16x16x32_bf16 v[104:107], a[240:243], a[8:11], 0
    ds_read_b64_tr_b16 a[228:229], v18 offset:10240
    ds_read_b64_tr_b16 a[230:231], v18 offset:10496
    v_mfma_f32_16x16x32_bf16 v[104:107], a[244:247], a[12:15], v[104:107]
    buffer_load_dwordx4 v10, s[68:71], s93 offen offset:2048  lds
    v_mfma_f32_16x16x32_bf16 v[112:115], a[240:243], a[16:19], 0
    v_add_f32 v180, v180, v181
    v_cvt_pk_bf16_f32 v181, v180, v180
    v_and_b32 v181, 0xffff0000, v181
    v_sub_f32 v181, v180, v181
    v_cvt_pk_bf16_f32 v204, v180, v181
    v_mfma_f32_16x16x32_bf16 v[112:115], a[244:247], a[20:23], v[112:115]
    v_and_b32 v180, 0xffff0000, v204
    v_sub_f32 v181, v181, v180
    v_cvt_pk_bf16_f32 v205, v181, 0
    v_add_f32 v184, v184, v185
    v_cvt_pk_bf16_f32 v185, v184, v184
    v_mfma_f32_16x16x32_bf16 v[120:123], a[240:243], a[24:27], 0
    v_and_b32 v185, 0xffff0000, v185
    v_sub_f32 v185, v184, v185
    v_cvt_pk_bf16_f32 v206, v184, v185
    v_and_b32 v184, 0xffff0000, v206
    v_mfma_f32_16x16x32_bf16 v[120:123], a[244:247], a[28:31], v[120:123]
    v_sub_f32 v185, v185, v184
    v_cvt_pk_bf16_f32 v207, v185, 0
    v_smfmac_f32_16x16x64_bf16 v[188:191], v[176:179], a[240:247], v209
    v_mfma_f32_16x16x16_bf16 v[64:67], v[196:197], v[204:205], v[64:67]
    s_xor_b32 s0, s47, 0
    s_mul_i32 s0, s0, 57344
    v_mfma_f32_16x16x16_bf16 v[68:71], v[198:199], v[204:205], v[68:71]
    s_xor_b32 s1, s47, 1
    s_mul_i32 s1, s1, 57344
    v_mfma_f32_16x16x16_bf16 v[72:75], v[200:201], v[204:205], v[72:75]
    s_xor_b32 s56, s47, 2
    s_mul_i32 s56, s56, 57344
    v_mfma_f32_16x16x16_bf16 v[76:79], v[202:203], v[204:205], v[76:79]
    s_xor_b32 s57, s47, 3
    s_mul_i32 s57, s57, 57344
    v_mfma_f32_16x16x16_bf16 v[80:83], v[196:197], v[206:207], v[80:83]
    s_cmp_lt_u32 s3, 2
    s_cselect_b64 s[48:49], s[0:1], s[56:57]
    s_cselect_b32 s52, s60, s64
    s_cselect_b32 s53, s61, s65
    v_mfma_f32_16x16x16_bf16 v[84:87], v[198:199], v[206:207], v[84:87]
    s_mov_b32 s54, 401408
    v_mfma_f32_16x16x16_bf16 v[88:91], v[200:201], v[206:207], v[88:91]
    v_mfma_f32_16x16x16_bf16 v[92:95], v[202:203], v[206:207], v[92:95]
    s_waitcnt lgkmcnt(4)
    v_mfma_f32_16x16x32_bf16 v[100:103], a[248:251], a[0:3], 0
    ds_read_b64_tr_b16 a[232:233], v19 offset:8192
    ds_read_b64_tr_b16 a[234:235], v19 offset:8448
    v_mfma_f32_16x16x32_bf16 v[100:103], a[252:255], a[4:7], v[100:103]
    buffer_load_dwordx4 v11, s[68:71], s93 offen offset:3072  lds
    v_mfma_f32_16x16x32_bf16 v[108:111], a[248:251], a[8:11], 0
    ds_read_b64_tr_b16 a[236:237], v19 offset:10240
    ds_read_b64_tr_b16 a[238:239], v19 offset:10496
    v_mfma_f32_16x16x32_bf16 v[108:111], a[252:255], a[12:15], v[108:111]
    s_add_u32 m0, s6, 4096
    s_mul_i32 s94, s94, 1792
    v_mov_b32 v180, 0
    v_mfma_f32_16x16x32_bf16 v[116:119], a[248:251], a[16:19], 0
    buffer_load_dwordx4 v8, s[68:71], s94 offen offset:0  lds
    v_mfma_f32_16x16x32_bf16 v[116:119], a[252:255], a[20:23], v[116:119]
    v_mov_b32 v181, 0
    v_mov_b32 v184, 0
    v_mov_b32 v185, 0
    v_mfma_f32_16x16x32_bf16 v[124:127], a[248:251], a[24:27], 0
    v_mul_f32 v64, v64, v128
    v_mul_f32 v80, v80, v128
    v_mfma_f32_16x16x32_bf16 v[124:127], a[252:255], a[28:31], v[124:127]
    v_mul_f32 v65, v65, v129
    v_mul_f32 v81, v81, v129
    v_smfmac_f32_16x16x64_bf16 v[192:195], v[176:179], a[248:255], v209
    s_waitcnt vmcnt(13) lgkmcnt(4)
    v_mfma_f32_16x16x32_bf16 v[96:99], a[224:227], a[32:35], v[96:99]
    ds_read_b64_tr_b16 a[240:241], v18 offset:12288
    ds_read_b64_tr_b16 a[242:243], v18 offset:12544
    v_mfma_f32_16x16x32_bf16 v[96:99], a[228:231], a[36:39], v[96:99]
    buffer_load_dwordx4 v9, s[68:71], s94 offen offset:1024  lds
    v_mfma_f32_16x16x32_bf16 v[104:107], a[224:227], a[40:43], v[104:107]
    ds_read_b64_tr_b16 a[244:245], v18 offset:14336
    ds_read_b64_tr_b16 a[246:247], v18 offset:14592
    v_mfma_f32_16x16x32_bf16 v[104:107], a[228:231], a[44:47], v[104:107]
    buffer_load_dwordx4 v10, s[68:71], s94 offen offset:2048  lds
    v_mfma_f32_16x16x32_bf16 v[112:115], a[224:227], a[48:51], v[112:115]
    v_mul_f32 v66, v66, v130
    v_mul_f32 v82, v82, v130
    v_mul_f32 v67, v67, v131
    v_mfma_f32_16x16x32_bf16 v[112:115], a[228:231], a[52:55], v[112:115]
    v_mul_f32 v83, v83, v131
    v_fma_f32 v244, v44, v64, v66
    v_fma_f32 v245, v44, v80, v82
    v_mfma_f32_16x16x32_bf16 v[120:123], a[224:227], a[56:59], v[120:123]
    v_fma_f32 v244, -v45, v80, v244
    v_fmac_f32 v245, v45, v64
    v_mfma_f32_16x16x32_bf16 v[120:123], a[228:231], a[60:63], v[120:123]
    v_fma_f32 v246, v44, v65, v67
    v_fma_f32 v247, v44, v81, v83
    v_smfmac_f32_16x16x64_bf16 v[188:191], v[176:179], a[224:231], v209
    s_waitcnt lgkmcnt(0)
    s_cmp_lt_u32 s46, 32
    s_cbranch_scc1 L_clr_spin
L_clr_ok:
    v_mfma_f32_16x16x32_bf16 v[100:103], a[232:235], a[32:35], v[100:103]
    ds_read_b64_tr_b16 a[248:249], v19 offset:12288
    ds_read_b64_tr_b16 a[250:251], v19 offset:12544
    v_mfma_f32_16x16x32_bf16 v[100:103], a[236:239], a[36:39], v[100:103]
    buffer_load_dwordx4 v11, s[68:71], s94 offen offset:3072  lds
    v_mfma_f32_16x16x32_bf16 v[108:111], a[232:235], a[40:43], v[108:111]
    ds_read_b64_tr_b16 a[252:253], v19 offset:14336
    ds_read_b64_tr_b16 a[254:255], v19 offset:14592
    v_mfma_f32_16x16x32_bf16 v[108:111], a[236:239], a[44:47], v[108:111]
    s_add_u32 m0, s6, 8192
    v_fma_f32 v246, -v45, v81, v246
    v_fmac_f32 v247, v45, v65
    v_mfma_f32_16x16x32_bf16 v[116:119], a[232:235], a[48:51], v[116:119]
    s_add_u32 s68, s68, 256
    s_addc_u32 s69, s69, 0
    v_mul_f32 v68, v68, v132
    v_mfma_f32_16x16x32_bf16 v[116:119], a[236:239], a[52:55], v[116:119]
    buffer_load_dwordx4 v8, s[68:71], s88 offen offset:0  lds
    v_mfma_f32_16x16x32_bf16 v[124:127], a[232:235], a[56:59], v[124:127]
    v_mul_f32 v84, v84, v132
    v_mul_f32 v69, v69, v133
    v_mfma_f32_16x16x32_bf16 v[124:127], a[236:239], a[60:63], v[124:127]
    v_mul_f32 v85, v85, v133
    v_fma_f32 v240, v44, v244, v68
    v_smfmac_f32_16x16x64_bf16 v[192:195], v[176:179], a[232:239], v209
    s_waitcnt vmcnt(13)
    v_mfma_f32_16x16x32_bf16 v[96:99], a[240:243], a[64:67], v[96:99]
    ds_read_b64_tr_b16 a[224:225], v18 offset:16384
    ds_read_b64_tr_b16 a[226:227], v18 offset:16640
    v_mfma_f32_16x16x32_bf16 v[96:99], a[244:247], a[68:71], v[96:99]
    buffer_load_dwordx4 v9, s[68:71], s88 offen offset:1024  lds
    v_mfma_f32_16x16x32_bf16 v[104:107], a[240:243], a[72:75], v[104:107]
    ds_read_b64_tr_b16 a[228:229], v18 offset:18432
    ds_read_b64_tr_b16 a[230:231], v18 offset:18688
    v_mfma_f32_16x16x32_bf16 v[104:107], a[244:247], a[76:79], v[104:107]
    buffer_load_dwordx4 v10, s[68:71], s88 offen offset:2048  lds
    v_mfma_f32_16x16x32_bf16 v[112:115], a[240:243], a[80:83], v[112:115]
    v_fma_f32 v241, v44, v245, v84
L_pg2:
    s_cbranch_execz L_pg_ret
    v_fma_f32 v240, -v45, v245, v240
    v_fmac_f32 v241, v45, v244
    v_mfma_f32_16x16x32_bf16 v[112:115], a[244:247], a[84:87], v[112:115]
    v_fma_f32 v242, v44, v246, v69
    v_fma_f32 v243, v44, v247, v85
    v_fma_f32 v242, -v45, v247, v242
    v_mfma_f32_16x16x32_bf16 v[120:123], a[240:243], a[88:91], v[120:123]
    v_fmac_f32 v243, v45, v246
    v_mul_f32 v70, v70, v134
    v_mfma_f32_16x16x32_bf16 v[120:123], a[244:247], a[92:95], v[120:123]
    v_mul_f32 v86, v86, v134
    v_mul_f32 v71, v71, v135
    v_smfmac_f32_16x16x64_bf16 v[188:191], v[176:179], a[240:247], v209
    s_waitcnt lgkmcnt(4)
    v_mfma_f32_16x16x32_bf16 v[100:103], a[248:251], a[64:67], v[100:103]
    ds_read_b64_tr_b16 a[232:233], v19 offset:16384
    ds_read_b64_tr_b16 a[234:235], v19 offset:16640
    v_mfma_f32_16x16x32_bf16 v[100:103], a[252:255], a[68:71], v[100:103]
    buffer_load_dwordx4 v11, s[68:71], s88 offen offset:3072  lds
    v_mfma_f32_16x16x32_bf16 v[108:111], a[248:251], a[72:75], v[108:111]
    ds_read_b64_tr_b16 a[236:237], v19 offset:18432
    ds_read_b64_tr_b16 a[238:239], v19 offset:18688
    v_mfma_f32_16x16x32_bf16 v[108:111], a[252:255], a[76:79], v[108:111]
    s_add_u32 m0, s6, 12288
    v_mul_f32 v87, v87, v135
    v_fma_f32 v244, v44, v240, v70
    v_mfma_f32_16x16x32_bf16 v[116:119], a[248:251], a[80:83], v[116:119]
    buffer_load_dwordx4 v8, s[68:71], s89 offen offset:0  lds
    v_mfma_f32_16x16x32_bf16 v[116:119], a[252:255], a[84:87], v[116:119]
    v_fma_f32 v245, v44, v241, v86
    v_fma_f32 v244, -v45, v241, v244
    v_fmac_f32 v245, v45, v240
    v_mfma_f32_16x16x32_bf16 v[124:127], a[248:251], a[88:91], v[124:127]
    v_fma_f32 v246, v44, v242, v71
    v_fma_f32 v247, v44, v243, v87
    v_mfma_f32_16x16x32_bf16 v[124:127], a[252:255], a[92:95], v[124:127]
    v_fma_f32 v246, -v45, v243, v246
    v_fmac_f32 v247, v45, v242
    v_smfmac_f32_16x16x64_bf16 v[192:195], v[176:179], a[248:255], v209
    s_waitcnt vmcnt(13) lgkmcnt(4)
    v_mfma_f32_16x16x32_bf16 v[96:99], a[224:227], a[96:99], v[96:99]
    ds_read_b64_tr_b16 a[240:241], v18 offset:20480
    ds_read_b64_tr_b16 a[242:243], v18 offset:20736
    v_mfma_f32_16x16x32_bf16 v[96:99], a[228:231], a[100:103], v[96:99]
    buffer_load_dwordx4 v9, s[68:71], s89 offen offset:1024  lds
    v_mfma_f32_16x16x32_bf16 v[104:107], a[224:227], a[104:107], v[104:107]
    ds_read_b64_tr_b16 a[244:245], v18 offset:22528
    ds_read_b64_tr_b16 a[246:247], v18 offset:22784
    v_mfma_f32_16x16x32_bf16 v[104:107], a[228:231], a[108:111], v[104:107]
    buffer_load_dwordx4 v10, s[68:71], s89 offen offset:2048  lds
    v_mfma_f32_16x16x32_bf16 v[112:115], a[224:227], a[112:115], v[112:115]
    v_mul_f32 v72, v72, v136
    v_mul_f32 v88, v88, v136
    v_mul_f32 v73, v73, v137
    v_mfma_f32_16x16x32_bf16 v[112:115], a[228:231], a[116:119], v[112:115]
    v_mul_f32 v89, v89, v137
    v_fma_f32 v240, v44, v244, v72
    v_fma_f32 v241, v44, v245, v88
    v_mfma_f32_16x16x32_bf16 v[120:123], a[224:227], a[120:123], v[120:123]
    v_fma_f32 v240, -v45, v245, v240
    v_fmac_f32 v241, v45, v244
    v_mfma_f32_16x16x32_bf16 v[120:123], a[228:231], a[124:127], v[120:123]
    v_fma_f32 v242, v44, v246, v73
    v_fma_f32 v243, v44, v247, v89
    v_smfmac_f32_16x16x64_bf16 v[188:191], v[176:179], a[224:231], v209
    s_waitcnt lgkmcnt(4)
    v_mfma_f32_16x16x32_bf16 v[100:103], a[232:235], a[96:99], v[100:103]
    ds_read_b64_tr_b16 a[248:249], v19 offset:20480
    ds_read_b64_tr_b16 a[250:251], v19 offset:20736
    v_mfma_f32_16x16x32_bf16 v[100:103], a[236:239], a[100:103], v[100:103]
    buffer_load_dwordx4 v11, s[68:71], s89 offen offset:3072  lds
    v_mfma_f32_16x16x32_bf16 v[108:111], a[232:235], a[104:107], v[108:111]
    ds_read_b64_tr_b16 a[252:253], v19 offset:22528
    ds_read_b64_tr_b16 a[254:255], v19 offset:22784
    v_mfma_f32_16x16x32_bf16 v[108:111], a[236:239], a[108:111], v[108:111]
    s_add_u32 m0, s6, 16384
    v_fma_f32 v242, -v45, v247, v242
    v_fmac_f32 v243, v45, v246
    v_mfma_f32_16x16x32_bf16 v[116:119], a[232:235], a[112:115], v[116:119]
    buffer_load_dwordx4 v8, s[68:71], s90 offen offset:0  lds
    v_mfma_f32_16x16x32_bf16 v[116:119], a[236:239], a[116:119], v[116:119]
    v_mul_f32 v74, v74, v138
    v_mul_f32 v90, v90, v138
    v_mul_f32 v75, v75, v139
    v_mfma_f32_16x16x32_bf16 v[124:127], a[232:235], a[120:123], v[124:127]
    v_mul_f32 v91, v91, v139
    v_fma_f32 v244, v44, v240, v74
    v_mfma_f32_16x16x32_bf16 v[124:127], a[236:239], a[124:127], v[124:127]
    v_fma_f32 v245, v44, v241, v90
    v_fma_f32 v244, -v45, v241, v244
    v_smfmac_f32_16x16x64_bf16 v[192:195], v[176:179], a[232:239], v209
    s_waitcnt vmcnt(13) lgkmcnt(4)
    v_mfma_f32_16x16x32_bf16 v[96:99], a[240:243], a[128:131], v[96:99]
    ds_read_b64_tr_b16 a[224:225], v18 offset:0
    ds_read_b64_tr_b16 a[226:227], v18 offset:256
    v_mfma_f32_16x16x32_bf16 v[96:99], a[244:247], a[132:135], v[96:99]
    buffer_load_dwordx4 v9, s[68:71], s90 offen offset:1024  lds
    v_mfma_f32_16x16x32_bf16 v[104:107], a[240:243], a[136:139], v[104:107]
    ds_read_b64_tr_b16 a[228:229], v18 offset:2048
    ds_read_b64_tr_b16 a[230:231], v18 offset:2304
    v_mfma_f32_16x16x32_bf16 v[104:107], a[244:247], a[140:143], v[104:107]
    buffer_load_dwordx4 v10, s[68:71], s90 offen offset:2048  lds
    v_mfma_f32_16x16x32_bf16 v[112:115], a[240:243], a[144:147], v[112:115]
    v_fmac_f32 v245, v45, v240
    v_fma_f32 v246, v44, v242, v75
    v_fma_f32 v247, v44, v243, v91
    v_mfma_f32_16x16x32_bf16 v[112:115], a[244:247], a[148:151], v[112:115]
    v_fma_f32 v246, -v45, v243, v246
    v_fmac_f32 v247, v45, v242
    v_mul_f32 v76, v76, v140
    v_mfma_f32_16x16x32_bf16 v[120:123], a[240:243], a[152:155], v[120:123]
    v_mul_f32 v92, v92, v140
    v_mul_f32 v77, v77, v141
    v_mfma_f32_16x16x32_bf16 v[120:123], a[244:247], a[156:159], v[120:123]
    v_mul_f32 v93, v93, v141
    v_fma_f32 v240, v44, v244, v76
    v_smfmac_f32_16x16x64_bf16 v[188:191], v[176:179], a[240:247], v209
    s_waitcnt lgkmcnt(4)
    v_mfma_f32_16x16x32_bf16 v[100:103], a[248:251], a[128:131], v[100:103]
    ds_read_b64_tr_b16 a[232:233], v19 offset:0
    ds_read_b64_tr_b16 a[234:235], v19 offset:256
    v_mfma_f32_16x16x32_bf16 v[100:103], a[252:255], a[132:135], v[100:103]
    buffer_load_dwordx4 v11, s[68:71], s90 offen offset:3072  lds
    v_mfma_f32_16x16x32_bf16 v[108:111], a[248:251], a[136:139], v[108:111]
    ds_read_b64_tr_b16 a[236:237], v19 offset:2048
    ds_read_b64_tr_b16 a[238:239], v19 offset:2304
    v_mfma_f32_16x16x32_bf16 v[108:111], a[252:255], a[140:143], v[108:111]
    s_add_u32 m0, s6, 20480
    v_fma_f32 v241, v44, v245, v92
    v_fma_f32 v240, -v45, v245, v240
    v_mfma_f32_16x16x32_bf16 v[116:119], a[248:251], a[144:147], v[116:119]
    buffer_load_dwordx4 v8, s[68:71], s91 offen offset:0  lds
    v_mfma_f32_16x16x32_bf16 v[116:119], a[252:255], a[148:151], v[116:119]
    v_fmac_f32 v241, v45, v244
    v_fma_f32 v242, v44, v246, v77
    v_fma_f32 v243, v44, v247, v93
    v_mfma_f32_16x16x32_bf16 v[124:127], a[248:251], a[152:155], v[124:127]
    v_fma_f32 v242, -v45, v247, v242
    v_fmac_f32 v243, v45, v246
    v_mfma_f32_16x16x32_bf16 v[124:127], a[252:255], a[156:159], v[124:127]
    v_mul_f32 v78, v78, v142
    v_mul_f32 v94, v94, v142
    v_smfmac_f32_16x16x64_bf16 v[192:195], v[176:179], a[248:255], v209
    s_waitcnt vmcnt(13) lgkmcnt(4)
    v_mfma_f32_16x16x32_bf16 v[96:99], a[224:227], a[160:163], v[96:99]
    ds_read_b64_tr_b16 a[240:241], v18 offset:4096
    ds_read_b64_tr_b16 a[242:243], v18 offset:4352
    v_mfma_f32_16x16x32_bf16 v[96:99], a[228:231], a[164:167], v[96:99]
    buffer_load_dwordx4 v9, s[68:71], s91 offen offset:1024  lds
    v_mfma_f32_16x16x32_bf16 v[104:107], a[224:227], a[168:171], v[104:107]
    ds_read_b64_tr_b16 a[244:245], v18 offset:6144
    ds_read_b64_tr_b16 a[246:247], v18 offset:6400
    v_mfma_f32_16x16x32_bf16 v[104:107], a[228:231], a[172:175], v[104:107]
    buffer_load_dwordx4 v10, s[68:71], s91 offen offset:2048  lds
    v_mfma_f32_16x16x32_bf16 v[112:115], a[224:227], a[176:179], v[112:115]
    v_mul_f32 v79, v79, v143
    v_mul_f32 v95, v95, v143
    v_fma_f32 v216, v44, v240, v78
    v_mfma_f32_16x16x32_bf16 v[112:115], a[228:231], a[180:183], v[112:115]
    v_fma_f32 v217, v44, v241, v94
    v_fma_f32 v216, -v45, v241, v216
    v_fmac_f32 v217, v45, v240
    v_mfma_f32_16x16x32_bf16 v[120:123], a[224:227], a[184:187], v[120:123]
    v_fma_f32 v218, v44, v242, v79
    v_fma_f32 v219, v44, v243, v95
    v_mfma_f32_16x16x32_bf16 v[120:123], a[228:231], a[188:191], v[120:123]
    v_fma_f32 v218, -v45, v243, v218
    v_fmac_f32 v219, v45, v242
    v_smfmac_f32_16x16x64_bf16 v[188:191], v[176:179], a[224:231], v209
    s_barrier
    s_waitcnt lgkmcnt(4)
    v_mfma_f32_16x16x32_bf16 v[100:103], a[232:235], a[160:163], v[100:103]
    ds_read_b64_tr_b16 a[248:249], v19 offset:4096
    ds_read_b64_tr_b16 a[250:251], v19 offset:4352
    v_mfma_f32_16x16x32_bf16 v[100:103], a[236:239], a[164:167], v[100:103]
    buffer_load_dwordx4 v11, s[68:71], s91 offen offset:3072  lds
    v_mfma_f32_16x16x32_bf16 v[108:111], a[232:235], a[168:171], v[108:111]
    ds_read_b64_tr_b16 a[252:253], v19 offset:6144
    ds_read_b64_tr_b16 a[254:255], v19 offset:6400
    v_mfma_f32_16x16x32_bf16 v[108:111], a[236:239], a[172:175], v[108:111]
    s_add_u32 m0, s6, 0
    v_fmac_f32 v218, v48, v216
    v_fmac_f32 v219, v48, v217
    v_mfma_f32_16x16x32_bf16 v[116:119], a[232:235], a[176:179], v[116:119]
    buffer_load_dwordx4 v8, s[68:71], s92 offen offset:0  lds
    v_mfma_f32_16x16x32_bf16 v[116:119], a[236:239], a[180:183], v[116:119]
    v_fma_f32 v218, -v49, v217, v218
    v_fmac_f32 v219, v49, v216
    v_mov_b32 v220, v218
    v_mfma_f32_16x16x32_bf16 v[124:127], a[232:235], a[184:187], v[124:127]
    v_mov_b32 v221, v219
    v_permlane16_swap_b32 v218, v220
    v_mfma_f32_16x16x32_bf16 v[124:127], a[236:239], a[188:191], v[124:127]
    v_permlane16_swap_b32 v219, v221
    v_fmac_f32 v220, v50, v218
    v_smfmac_f32_16x16x64_bf16 v[192:195], v[176:179], a[232:239], v209
    s_waitcnt vmcnt(13) lgkmcnt(4)
    v_mfma_f32_16x16x32_bf16 v[96:99], a[240:243], a[192:195], v[96:99]
    ds_read_b64_tr_b16 a[224:225], v18 offset:8192
    ds_read_b64_tr_b16 a[226:227], v18 offset:8448
    v_mfma_f32_16x16x32_bf16 v[96:99], a[244:247], a[196:199], v[96:99]
    buffer_load_dwordx4 v9, s[68:71], s92 offen offset:1024  lds
    v_mfma_f32_16x16x32_bf16 v[104:107], a[240:243], a[200:203], v[104:107]
    ds_read_b64_tr_b16 a[228:229], v18 offset:10240
    ds_read_b64_tr_b16 a[230:231], v18 offset:10496
    v_mfma_f32_16x16x32_bf16 v[104:107], a[244:247], a[204:207], v[104:107]
    buffer_load_dwordx4 v10, s[68:71], s92 offen offset:2048  lds
    v_mfma_f32_16x16x32_bf16 v[112:115], a[240:243], a[208:211], v[112:115]
    v_fmac_f32 v221, v50, v219
    v_fma_f32 v220, -v51, v219, v220
    v_fmac_f32 v221, v51, v218
    v_mfma_f32_16x16x32_bf16 v[112:115], a[244:247], a[212:215], v[112:115]
    v_mov_b32 v222, v220
    v_mov_b32 v223, v221
    s_nop 0
    v_permlane32_swap_b32 v220, v222
    v_mfma_f32_16x16x32_bf16 v[120:123], a[240:243], a[216:219], v[120:123]
    v_permlane32_swap_b32 v221, v223
    v_fmac_f32 v222, v52, v220
    v_mfma_f32_16x16x32_bf16 v[120:123], a[244:247], a[220:223], v[120:123]
    v_fmac_f32 v223, v52, v221
    v_fma_f32 v222, -v53, v221, v222
    v_smfmac_f32_16x16x64_bf16 v[188:191], v[176:179], a[240:247], v209
    s_waitcnt lgkmcnt(4)
    v_mfma_f32_16x16x32_bf16 v[100:103], a[248:251], a[192:195], v[100:103]
    ds_read_b64_tr_b16 a[232:233], v19 offset:8192
    ds_read_b64_tr_b16 a[234:235], v19 offset:8448
    v_mfma_f32_16x16x32_bf16 v[100:103], a[252:255], a[196:199], v[100:103]
    buffer_load_dwordx4 v11, s[68:71], s92 offen offset:3072  lds
    v_mfma_f32_16x16x32_bf16 v[108:111], a[248:251], a[200:203], v[108:111]
    ds_read_b64_tr_b16 a[236:237], v19 offset:10240
    ds_read_b64_tr_b16 a[238:239], v19 offset:10496
    v_mfma_f32_16x16x32_bf16 v[108:111], a[252:255], a[204:207], v[108:111]
    s_add_u32 m0, s6, 4096
    v_fmac_f32 v223, v53, v220
    v_min_u32 v222, -2, v222
    v_mfma_f32_16x16x32_bf16 v[116:119], a[248:251], a[208:211], v[116:119]
    buffer_load_dwordx4 v8, s[68:71], s93 offen offset:0  lds
    v_mfma_f32_16x16x32_bf16 v[116:119], a[252:255], a[212:215], v[116:119]
    v_min_u32 v223, -2, v223
    v_mfma_f32_16x16x32_bf16 v[124:127], a[248:251], a[216:219], v[124:127]
    buffer_store_dwordx2 v[222:223], v43, s[84:87], 0 offen sc1
    v_mfma_f32_16x16x32_bf16 v[124:127], a[252:255], a[220:223], v[124:127]
    v_smfmac_f32_16x16x64_bf16 v[192:195], v[176:179], a[248:255], v209
    s_waitcnt vmcnt(14) lgkmcnt(4)
    v_mfma_f32_16x16x32_bf16 v[128:131], a[224:227], a[0:3], 0
    ds_read_b64_tr_b16 a[240:241], v18 offset:12288
    ds_read_b64_tr_b16 a[242:243], v18 offset:12544
    v_mfma_f32_16x16x32_bf16 v[128:131], a[228:231], a[4:7], v[128:131]
    buffer_load_dwordx4 v9, s[68:71], s93 offen offset:1024  lds
    v_mfma_f32_16x16x32_bf16 v[136:139], a[224:227], a[8:11], 0
    ds_read_b64_tr_b16 a[244:245], v18 offset:14336
    ds_read_b64_tr_b16 a[246:247], v18 offset:14592
    v_mfma_f32_16x16x32_bf16 v[136:139], a[228:231], a[12:15], v[136:139]
    buffer_load_dwordx4 v10, s[68:71], s93 offen offset:2048  lds
    v_mfma_f32_16x16x32_bf16 v[144:147], a[224:227], a[16:19], 0
    v_add_f32 v188, v188, v189
    v_mov_b32 v190, 0
    v_cvt_pk_bf16_f32 v189, v188, v188
    v_and_b32 v189, 0xffff0000, v189
    v_sub_f32 v189, v188, v189
    v_mfma_f32_16x16x32_bf16 v[144:147], a[228:231], a[20:23], v[144:147]
    v_cvt_pk_bf16_f32 v204, v188, v189
    v_and_b32 v188, 0xffff0000, v204
    v_sub_f32 v189, v189, v188
    v_mov_b32_dpp v190, v208 quad_perm:[0,1,2,3] row_mask:1 bank_mask:0xf
    v_cvt_pk_bf16_f32 v205, v189, v190
    v_mfma_f32_16x16x32_bf16 v[152:155], a[224:227], a[24:27], 0
    v_add_f32 v192, v192, v193
    v_mov_b32 v194, 0
    v_cvt_pk_bf16_f32 v193, v192, v192
    v_and_b32 v193, 0xffff0000, v193
    v_mfma_f32_16x16x32_bf16 v[152:155], a[228:231], a[28:31], v[152:155]
    v_sub_f32 v193, v192, v193
    v_cvt_pk_bf16_f32 v206, v192, v193
    v_and_b32 v192, 0xffff0000, v206
    v_sub_f32 v193, v193, v192
    v_smfmac_f32_16x16x64_bf16 v[180:183], v[176:179], a[224:231], v209
    v_mov_b32_dpp v194, v208 quad_perm:[0,1,2,3] row_mask:2 bank_mask:0xf
    v_cvt_pk_bf16_f32 v207, v193, v194
    v_mfma_f32_16x16x16_bf16 v[96:99], v[204:205], v[196:197], v[96:99]
    v_mfma_f32_16x16x16_bf16 v[104:107], v[204:205], v[198:199], v[104:107]
    v_mfma_f32_16x16x16_bf16 v[112:115], v[204:205], v[200:201], v[112:115]
    v_mfma_f32_16x16x16_bf16 v[120:123], v[204:205], v[202:203], v[120:123]
    v_mfma_f32_16x16x16_bf16 v[100:103], v[206:207], v[196:197], v[100:103]
    v_mfma_f32_16x16x16_bf16 v[108:111], v[206:207], v[198:199], v[108:111]
    v_mfma_f32_16x16x16_bf16 v[116:119], v[206:207], v[200:201], v[116:119]
    v_mfma_f32_16x16x16_bf16 v[124:127], v[206:207], v[202:203], v[124:127]
    s_waitcnt lgkmcnt(4)
    v_mfma_f32_16x16x32_bf16 v[132:135], a[232:235], a[0:3], 0
    ds_read_b64_tr_b16 a[248:249], v19 offset:12288
    ds_read_b64_tr_b16 a[250:251], v19 offset:12544
    v_mfma_f32_16x16x32_bf16 v[132:135], a[236:239], a[4:7], v[132:135]
    buffer_load_dwordx4 v11, s[68:71], s93 offen offset:3072  lds
    v_mfma_f32_16x16x32_bf16 v[140:143], a[232:235], a[8:11], 0
    ds_read_b64_tr_b16 a[252:253], v19 offset:14336
    ds_read_b64_tr_b16 a[254:255], v19 offset:14592
    v_mfma_f32_16x16x32_bf16 v[140:143], a[236:239], a[12:15], v[140:143]
    s_add_u32 m0, s6, 8192
    v_mul_f32 v96, v96, v60
    v_mul_f32 v97, v97, v60
    v_mfma_f32_16x16x32_bf16 v[148:151], a[232:235], a[16:19], 0
    buffer_load_dwordx4 v8, s[68:71], s94 offen offset:0  lds
    v_mfma_f32_16x16x32_bf16 v[148:151], a[236:239], a[20:23], v[148:151]
    v_mul_f32 v98, v98, v60
    v_mul_f32 v99, v99, v60
    v_mfma_f32_16x16x32_bf16 v[156:159], a[232:235], a[24:27], 0
    v_exp_f32 v240, v96
    v_mfma_f32_16x16x32_bf16 v[156:159], a[236:239], a[28:31], v[156:159]
    v_exp_f32 v241, v97
    v_smfmac_f32_16x16x64_bf16 v[184:187], v[176:179], a[232:239], v209
    s_waitcnt vmcnt(14) lgkmcnt(4)
    v_mfma_f32_16x16x32_bf16 v[128:131], a[240:243], a[32:35], v[128:131]
    ds_read_b64_tr_b16 a[224:225], v18 offset:16384
    ds_read_b64_tr_b16 a[226:227], v18 offset:16640
    v_mfma_f32_16x16x32_bf16 v[128:131], a[244:247], a[36:39], v[128:131]
    buffer_load_dwordx4 v9, s[68:71], s94 offen offset:1024  lds
    v_mfma_f32_16x16x32_bf16 v[136:139], a[240:243], a[40:43], v[136:139]
    ds_read_b64_tr_b16 a[228:229], v18 offset:18432
    ds_read_b64_tr_b16 a[230:231], v18 offset:18688
    v_mfma_f32_16x16x32_bf16 v[136:139], a[244:247], a[44:47], v[136:139]
    buffer_load_dwordx4 v10, s[68:71], s94 offen offset:2048  lds
    v_mfma_f32_16x16x32_bf16 v[144:147], a[240:243], a[48:51], v[144:147]
    v_exp_f32 v242, v98
    v_mfma_f32_16x16x32_bf16 v[144:147], a[244:247], a[52:55], v[144:147]
    v_exp_f32 v243, v99
    v_fma_f32 v244, v240, 0.5, 1.0
    v_mfma_f32_16x16x32_bf16 v[152:155], a[240:243], a[56:59], v[152:155]
    v_fma_f32 v245, v241, 0.5, 1.0
    v_fma_f32 v246, v242, 0.5, 1.0
    v_mfma_f32_16x16x32_bf16 v[152:155], a[244:247], a[60:63], v[152:155]
    v_fma_f32 v247, v243, 0.5, 1.0
    v_fma_f32 v244, v240, v244, 1.0
    v_smfmac_f32_16x16x64_bf16 v[180:183], v[176:179], a[240:247], v209
    s_waitcnt lgkmcnt(4)
    v_mfma_f32_16x16x32_bf16 v[132:135], a[248:251], a[32:35], v[132:135]
    ds_read_b64_tr_b16 a[232:233], v19 offset:16384
    ds_read_b64_tr_b16 a[234:235], v19 offset:16640
    v_mfma_f32_16x16x32_bf16 v[132:135], a[252:255], a[36:39], v[132:135]
    buffer_load_dwordx4 v11, s[68:71], s94 offen offset:3072  lds
    v_mfma_f32_16x16x32_bf16 v[140:143], a[248:251], a[40:43], v[140:143]
    ds_read_b64_tr_b16 a[236:237], v19 offset:18432
    ds_read_b64_tr_b16 a[238:239], v19 offset:18688
    v_mfma_f32_16x16x32_bf16 v[140:143], a[252:255], a[44:47], v[140:143]
    s_add_u32 m0, s6, 12288
    s_add_u32 s7, s16, s0
    v_fma_f32 v245, v241, v245, 1.0
    v_mfma_f32_16x16x32_bf16 v[148:151], a[248:251], a[48:51], v[148:151]
    buffer_load_dwordx4 v12, s[72:75], s7 offen offset:0  lds
    v_mfma_f32_16x16x32_bf16 v[148:151], a[252:255], a[52:55], v[148:151]
    v_fma_f32 v246, v242, v246, 1.0
    v_fma_f32 v247, v243, v247, 1.0
    v_mfma_f32_16x16x32_bf16 v[156:159], a[248:251], a[56:59], v[156:159]
    v_rcp_f32 v244, v244
    v_mfma_f32_16x16x32_bf16 v[156:159], a[252:255], a[60:63], v[156:159]
    v_rcp_f32 v245, v245
    v_smfmac_f32_16x16x64_bf16 v[184:187], v[176:179], a[248:255], v209
    s_waitcnt vmcnt(14) lgkmcnt(4)
    v_mfma_f32_16x16x32_bf16 v[128:131], a[224:227], a[64:67], v[128:131]
    ds_read_b64_tr_b16 a[240:241], v18 offset:20480
    ds_read_b64_tr_b16 a[242:243], v18 offset:20736
    v_mfma_f32_16x16x32_bf16 v[128:131], a[228:231], a[68:71], v[128:131]
    buffer_load_dwordx4 v13, s[72:75], s7 offen offset:1024  lds
    v_mfma_f32_16x16x32_bf16 v[136:139], a[224:227], a[72:75], v[136:139]
    ds_read_b64_tr_b16 a[244:245], v18 offset:22528
    ds_read_b64_tr_b16 a[246:247], v18 offset:22784
    v_mfma_f32_16x16x32_bf16 v[136:139], a[228:231], a[76:79], v[136:139]
    buffer_load_dwordx4 v14, s[72:75], s7 offen offset:2048  lds
    v_mfma_f32_16x16x32_bf16 v[144:147], a[224:227], a[80:83], v[144:147]
    v_rcp_f32 v246, v246
    v_mfma_f32_16x16x32_bf16 v[144:147], a[228:231], a[84:87], v[144:147]
    v_rcp_f32 v247, v247
    v_fma_f32 v96, -v96, v244, v96
    v_mfma_f32_16x16x32_bf16 v[152:155], a[224:227], a[88:91], v[152:155]
    v_fma_f32 v97, -v97, v245, v97
    v_fma_f32 v98, -v98, v246, v98
    v_mfma_f32_16x16x32_bf16 v[152:155], a[228:231], a[92:95], v[152:155]
    v_fma_f32 v99, -v99, v247, v99
    v_cvt_pk_bf16_f32 v96, v96, v97
    v_smfmac_f32_16x16x64_bf16 v[180:183], v[176:179], a[224:231], v209
    s_waitcnt lgkmcnt(4)
    v_mfma_f32_16x16x32_bf16 v[132:135], a[232:235], a[64:67], v[132:135]
    ds_read_b64_tr_b16 a[248:249], v19 offset:20480
    ds_read_b64_tr_b16 a[250:251], v19 offset:20736
    v_mfma_f32_16x16x32_bf16 v[132:135], a[236:239], a[68:71], v[132:135]
    buffer_load_dwordx4 v15, s[72:75], s7 offen offset:3072  lds
    v_mfma_f32_16x16x32_bf16 v[140:143], a[232:235], a[72:75], v[140:143]
    ds_read_b64_tr_b16 a[252:253], v19 offset:22528
    ds_read_b64_tr_b16 a[254:255], v19 offset:22784
    v_mfma_f32_16x16x32_bf16 v[140:143], a[236:239], a[76:79], v[140:143]
    s_add_u32 m0, s6, 16384
    s_add_u32 s7, s16, s1
    v_cvt_pk_bf16_f32 v97, v98, v99
    v_mfma_f32_16x16x32_bf16 v[148:151], a[232:235], a[80:83], v[148:151]
    buffer_load_dwordx4 v12, s[72:75], s7 offen offset:0  lds
    v_mfma_f32_16x16x32_bf16 v[148:151], a[236:239], a[84:87], v[148:151]
    v_mul_f32 v100, v100, v60
    v_mul_f32 v101, v101, v60
    v_mul_f32 v102, v102, v60
    v_mfma_f32_16x16x32_bf16 v[156:159], a[232:235], a[88:91], v[156:159]
    v_mul_f32 v103, v103, v60
    v_mfma_f32_16x16x32_bf16 v[156:159], a[236:239], a[92:95], v[156:159]
    v_exp_f32 v240, v100
    v_smfmac_f32_16x16x64_bf16 v[184:187], v[176:179], a[232:239], v209
    s_waitcnt vmcnt(14) lgkmcnt(4)
    v_mfma_f32_16x16x32_bf16 v[128:131], a[240:243], a[96:99], v[128:131]
    ds_read_b64_tr_b16 a[224:225], v18 offset:0
    ds_read_b64_tr_b16 a[226:227], v18 offset:256
    v_mfma_f32_16x16x32_bf16 v[128:131], a[244:247], a[100:103], v[128:131]
    buffer_load_dwordx4 v13, s[72:75], s7 offen offset:1024  lds
    v_mfma_f32_16x16x32_bf16 v[136:139], a[240:243], a[104:107], v[136:139]
    ds_read_b64_tr_b16 a[228:229], v18 offset:2048
    ds_read_b64_tr_b16 a[230:231], v18 offset:2304
    v_mfma_f32_16x16x32_bf16 v[136:139], a[244:247], a[108:111], v[136:139]
    buffer_load_dwordx4 v14, s[72:75], s7 offen offset:2048  lds
    v_mfma_f32_16x16x32_bf16 v[144:147], a[240:243], a[112:115], v[144:147]
    buffer_load_dwordx4 v15, s[72:75], s7 offen offset:3072  lds
    v_mfma_f32_16x16x32_bf16 v[144:147], a[244:247], a[116:119], v[144:147]
    v_exp_f32 v241, v101
    v_mfma_f32_16x16x32_bf16 v[152:155], a[240:243], a[120:123], v[152:155]
    v_exp_f32 v242, v102
    v_mfma_f32_16x16x32_bf16 v[152:155], a[244:247], a[124:127], v[152:155]
    v_exp_f32 v243, v103
    v_smfmac_f32_16x16x64_bf16 v[180:183], v[176:179], a[240:247], v209
    s_waitcnt lgkmcnt(4)
    v_mfma_f32_16x16x32_bf16 v[132:135], a[248:251], a[96:99], v[132:135]
    ds_read_b64_tr_b16 a[232:233], v19 offset:0
    ds_read_b64_tr_b16 a[234:235], v19 offset:256
    v_mfma_f32_16x16x32_bf16 v[132:135], a[252:255], a[100:103], v[132:135]
    s_add_u32 m0, s6, 20480
    s_add_u32 s7, s16, s56
    v_fma_f32 v244, v240, 0.5, 1.0
    v_mfma_f32_16x16x32_bf16 v[140:143], a[248:251], a[104:107], v[140:143]
    ds_read_b64_tr_b16 a[236:237], v19 offset:2048
    ds_read_b64_tr_b16 a[238:239], v19 offset:2304
    v_mfma_f32_16x16x32_bf16 v[140:143], a[252:255], a[108:111], v[140:143]
    buffer_load_dwordx4 v12, s[72:75], s7 offen offset:0  lds
    v_mfma_f32_16x16x32_bf16 v[148:151], a[248:251], a[112:115], v[148:151]
    buffer_load_dwordx4 v13, s[72:75], s7 offen offset:1024  lds
    v_mfma_f32_16x16x32_bf16 v[148:151], a[252:255], a[116:119], v[148:151]
    v_fma_f32 v245, v241, 0.5, 1.0
    v_fma_f32 v246, v242, 0.5, 1.0
    v_fma_f32 v247, v243, 0.5, 1.0
    v_mfma_f32_16x16x32_bf16 v[156:159], a[248:251], a[120:123], v[156:159]
    v_fma_f32 v244, v240, v244, 1.0
    v_fma_f32 v245, v241, v245, 1.0
    v_mfma_f32_16x16x32_bf16 v[156:159], a[252:255], a[124:127], v[156:159]
    v_fma_f32 v246, v242, v246, 1.0
    v_fma_f32 v247, v243, v247, 1.0
    v_smfmac_f32_16x16x64_bf16 v[184:187], v[176:179], a[248:255], v209
    s_waitcnt vmcnt(14) lgkmcnt(4)
    v_mfma_f32_16x16x32_bf16 v[128:131], a[224:227], a[128:131], v[128:131]
    ds_read_b64_tr_b16 a[240:241], v18 offset:4096
    ds_read_b64_tr_b16 a[242:243], v18 offset:4352
    v_mfma_f32_16x16x32_bf16 v[128:131], a[228:231], a[132:135], v[128:131]
    buffer_load_dwordx4 v14, s[72:75], s7 offen offset:2048  lds
    v_mfma_f32_16x16x32_bf16 v[136:139], a[224:227], a[136:139], v[136:139]
    ds_read_b64_tr_b16 a[244:245], v18 offset:6144
    ds_read_b64_tr_b16 a[246:247], v18 offset:6400
    v_mfma_f32_16x16x32_bf16 v[136:139], a[228:231], a[140:143], v[136:139]
    buffer_load_dwordx4 v15, s[72:75], s7 offen offset:3072  lds
    v_mfma_f32_16x16x32_bf16 v[144:147], a[224:227], a[144:147], v[144:147]
    v_rcp_f32 v244, v244
    v_mfma_f32_16x16x32_bf16 v[144:147], a[228:231], a[148:151], v[144:147]
    v_rcp_f32 v245, v245
    v_mfma_f32_16x16x32_bf16 v[152:155], a[224:227], a[152:155], v[152:155]
    v_rcp_f32 v246, v246
    v_mfma_f32_16x16x32_bf16 v[152:155], a[228:231], a[156:159], v[152:155]
    v_rcp_f32 v247, v247
    v_smfmac_f32_16x16x64_bf16 v[180:183], v[176:179], a[224:231], v209
    s_waitcnt lgkmcnt(4)
    v_mfma_f32_16x16x32_bf16 v[132:135], a[232:235], a[128:131], v[132:135]
    ds_read_b64_tr_b16 a[248:249], v19 offset:4096
    ds_read_b64_tr_b16 a[250:251], v19 offset:4352
    v_mfma_f32_16x16x32_bf16 v[132:135], a[236:239], a[132:135], v[132:135]
    s_add_u32 m0, s6, 0
    s_add_u32 s7, s16, s57
    v_fma_f32 v100, -v100, v244, v100
    v_mfma_f32_16x16x32_bf16 v[140:143], a[232:235], a[136:139], v[140:143]
    ds_read_b64_tr_b16 a[252:253], v19 offset:6144
    ds_read_b64_tr_b16 a[254:255], v19 offset:6400
    v_mfma_f32_16x16x32_bf16 v[140:143], a[236:239], a[140:143], v[140:143]
    buffer_load_dwordx4 v12, s[72:75], s7 offen offset:0  lds
    v_mfma_f32_16x16x32_bf16 v[148:151], a[232:235], a[144:147], v[148:151]
    buffer_load_dwordx4 v13, s[72:75], s7 offen offset:1024  lds
    v_mfma_f32_16x16x32_bf16 v[148:151], a[236:239], a[148:151], v[148:151]
    v_fma_f32 v101, -v101, v245, v101
    v_fma_f32 v102, -v102, v246, v102
    v_fma_f32 v103, -v103, v247, v103
    v_mfma_f32_16x16x32_bf16 v[156:159], a[232:235], a[152:155], v[156:159]
    v_cvt_pk_bf16_f32 v98, v100, v101
    v_cvt_pk_bf16_f32 v99, v102, v103
    v_mfma_f32_16x16x32_bf16 v[156:159], a[236:239], a[156:159], v[156:159]
    v_mul_f32 v104, v104, v61
    v_mul_f32 v105, v105, v61
    v_smfmac_f32_16x16x64_bf16 v[184:187], v[176:179], a[232:239], v209
    s_waitcnt vmcnt(14) lgkmcnt(4)
    v_mfma_f32_16x16x32_bf16 v[128:131], a[240:243], a[160:163], v[128:131]
    ds_read_b64_tr_b16 a[224:225], v18 offset:8192
    ds_read_b64_tr_b16 a[226:227], v18 offset:8448
    v_mfma_f32_16x16x32_bf16 v[128:131], a[244:247], a[164:167], v[128:131]
    buffer_load_dwordx4 v14, s[72:75], s7 offen offset:2048  lds
    v_mfma_f32_16x16x32_bf16 v[136:139], a[240:243], a[168:171], v[136:139]
    ds_read_b64_tr_b16 a[228:229], v18 offset:10240
    ds_read_b64_tr_b16 a[230:231], v18 offset:10496
    v_mfma_f32_16x16x32_bf16 v[136:139], a[244:247], a[172:175], v[136:139]
    buffer_load_dwordx4 v15, s[72:75], s7 offen offset:3072  lds
    v_mfma_f32_16x16x32_bf16 v[144:147], a[240:243], a[176:179], v[144:147]
    v_mul_f32 v106, v106, v61
    v_mul_f32 v107, v107, v61
    v_mfma_f32_16x16x32_bf16 v[144:147], a[244:247], a[180:183], v[144:147]
    v_exp_f32 v240, v104
    v_mfma_f32_16x16x32_bf16 v[152:155], a[240:243], a[184:187], v[152:155]
    v_exp_f32 v241, v105
    v_mfma_f32_16x16x32_bf16 v[152:155], a[244:247], a[188:191], v[152:155]
    v_exp_f32 v242, v106
    v_smfmac_f32_16x16x64_bf16 v[180:183], v[176:179], a[240:247], v209
    s_waitcnt lgkmcnt(4)
    v_mfma_f32_16x16x32_bf16 v[132:135], a[248:251], a[160:163], v[132:135]
    ds_read_b64_tr_b16 a[232:233], v19 offset:8192
    ds_read_b64_tr_b16 a[234:235], v19 offset:8448
    v_mfma_f32_16x16x32_bf16 v[132:135], a[252:255], a[164:167], v[132:135]
    s_add_u32 m0, s6, 4096
    v_exp_f32 v243, v107
    v_mfma_f32_16x16x32_bf16 v[140:143], a[248:251], a[168:171], v[140:143]
    ds_read_b64_tr_b16 a[236:237], v19 offset:10240
    ds_read_b64_tr_b16 a[238:239], v19 offset:10496
    v_mfma_f32_16x16x32_bf16 v[140:143], a[252:255], a[172:175], v[140:143]
    buffer_load_dwordx4 v4, s[60:63], s20 offen offset:0  lds
    v_mfma_f32_16x16x32_bf16 v[148:151], a[248:251], a[176:179], v[148:151]
    buffer_load_dwordx4 v5, s[60:63], s20 offen offset:1024  lds
    v_mfma_f32_16x16x32_bf16 v[148:151], a[252:255], a[180:183], v[148:151]
    v_fma_f32 v244, v240, 0.5, 1.0
    v_fma_f32 v245, v241, 0.5, 1.0
    v_fma_f32 v246, v242, 0.5, 1.0
    v_mfma_f32_16x16x32_bf16 v[156:159], a[248:251], a[184:187], v[156:159]
    v_fma_f32 v247, v243, 0.5, 1.0
    v_fma_f32 v244, v240, v244, 1.0
    v_mfma_f32_16x16x32_bf16 v[156:159], a[252:255], a[188:191], v[156:159]
    v_fma_f32 v245, v241, v245, 1.0
    v_fma_f32 v246, v242, v246, 1.0
    v_smfmac_f32_16x16x64_bf16 v[184:187], v[176:179], a[248:255], v209
    s_waitcnt lgkmcnt(4)
    v_mfma_f32_16x16x32_bf16 v[128:131], a[224:227], a[192:195], v[128:131]
    buffer_load_dwordx4 v6, s[60:63], s20 offen offset:2048  lds
    v_mfma_f32_16x16x32_bf16 v[128:131], a[228:231], a[196:199], v[128:131]
    buffer_load_dwordx4 v7, s[60:63], s20 offen offset:3072  lds
    v_mfma_f32_16x16x32_bf16 v[136:139], a[224:227], a[200:203], v[136:139]
    v_fma_f32 v247, v243, v247, 1.0
    v_rcp_f32 v244, v244
    v_mfma_f32_16x16x32_bf16 v[136:139], a[228:231], a[204:207], v[136:139]
    v_rcp_f32 v245, v245
    v_mfma_f32_16x16x32_bf16 v[144:147], a[224:227], a[208:211], v[144:147]
    v_rcp_f32 v246, v246
    v_mfma_f32_16x16x32_bf16 v[144:147], a[228:231], a[212:215], v[144:147]
    v_rcp_f32 v247, v247
    v_mfma_f32_16x16x32_bf16 v[152:155], a[224:227], a[216:219], v[152:155]
    v_fma_f32 v104, -v104, v244, v104
    v_fma_f32 v105, -v105, v245, v105
    v_mfma_f32_16x16x32_bf16 v[152:155], a[228:231], a[220:223], v[152:155]
    v_fma_f32 v106, -v106, v246, v106
    v_fma_f32 v107, -v107, v247, v107
    v_smfmac_f32_16x16x64_bf16 v[180:183], v[176:179], a[224:231], v209
    s_waitcnt lgkmcnt(0)
    v_mfma_f32_16x16x32_bf16 v[132:135], a[232:235], a[192:195], v[132:135]
    s_add_u32 m0, s6, 8192
    v_cvt_pk_bf16_f32 v104, v104, v105
    v_cvt_pk_bf16_f32 v105, v106, v107
    v_mfma_f32_16x16x32_bf16 v[132:135], a[236:239], a[196:199], v[132:135]
    buffer_load_dwordx4 v4, s[64:67], s20 offen offset:0  lds
    v_mfma_f32_16x16x32_bf16 v[140:143], a[232:235], a[200:203], v[140:143]
    buffer_load_dwordx4 v5, s[64:67], s20 offen offset:1024  lds
    v_mfma_f32_16x16x32_bf16 v[140:143], a[236:239], a[204:207], v[140:143]
    v_mul_f32 v108, v108, v61
    v_mul_f32 v109, v109, v61
L_pg3:
    s_cbranch_execz L_pg_ret
    v_mul_f32 v110, v110, v61
    v_mfma_f32_16x16x32_bf16 v[148:151], a[232:235], a[208:211], v[148:151]
    v_mul_f32 v111, v111, v61
    v_mfma_f32_16x16x32_bf16 v[148:151], a[236:239], a[212:215], v[148:151]
    v_exp_f32 v240, v108
    v_mfma_f32_16x16x32_bf16 v[156:159], a[232:235], a[216:219], v[156:159]
    v_exp_f32 v241, v109
    v_mfma_f32_16x16x32_bf16 v[156:159], a[236:239], a[220:223], v[156:159]
    v_exp_f32 v242, v110
    v_smfmac_f32_16x16x64_bf16 v[184:187], v[176:179], a[232:239], v209
    buffer_load_dwordx2 v[224:225], v42, s[84:87], 0 offen offset:0 sc1
    buffer_load_dwordx2 v[226:227], v42, s[84:87], 0 offen offset:128 sc1
    buffer_load_dwordx2 v[228:229], v42, s[84:87], 0 offen offset:256 sc1
    buffer_load_dwordx2 v[230:231], v42, s[84:87], 0 offen offset:384 sc1
    v_add_f32 v180, v180, v181
    v_mov_b32 v182, 0
    v_cvt_pk_bf16_f32 v181, v180, v180
    v_and_b32 v181, 0xffff0000, v181
    v_sub_f32 v181, v180, v181
    v_cvt_pk_bf16_f32 v204, v180, v181
    v_and_b32 v180, 0xffff0000, v204
    v_sub_f32 v181, v181, v180
    v_mov_b32_dpp v182, v208 quad_perm:[0,1,2,3] row_mask:4 bank_mask:0xf
    v_cvt_pk_bf16_f32 v205, v181, v182
    v_add_f32 v184, v184, v185
    v_mov_b32 v186, 0
    v_cvt_pk_bf16_f32 v185, v184, v184
    v_and_b32 v185, 0xffff0000, v185
    v_sub_f32 v185, v184, v185
    v_cvt_pk_bf16_f32 v206, v184, v185
    v_and_b32 v184, 0xffff0000, v206
    v_sub_f32 v185, v185, v184
    v_mov_b32_dpp v186, v208 quad_perm:[0,1,2,3] row_mask:8 bank_mask:0xf
    v_cvt_pk_bf16_f32 v207, v185, v186
    v_mfma_f32_16x16x16_bf16 v[128:131], v[204:205], v[196:197], v[128:131]
    buffer_load_dwordx2 v[232:233], v42, s[84:87], 0 offen offset:512 sc1
    buffer_load_dwordx2 v[234:235], v42, s[84:87], 0 offen offset:640 sc1
    v_mfma_f32_16x16x16_bf16 v[136:139], v[204:205], v[198:199], v[136:139]
    buffer_load_dwordx2 v[236:237], v42, s[84:87], 0 offen offset:768 sc1
    buffer_load_dwordx2 v[238:239], v42, s[84:87], 0 offen offset:896 sc1
    v_mfma_f32_16x16x16_bf16 v[144:147], v[204:205], v[200:201], v[144:147]
    v_exp_f32 v243, v111
    v_mfma_f32_16x16x16_bf16 v[152:155], v[204:205], v[202:203], v[152:155]
    v_fma_f32 v244, v240, 0.5, 1.0
    v_fma_f32 v245, v241, 0.5, 1.0
    v_mfma_f32_16x16x16_bf16 v[132:135], v[206:207], v[196:197], v[132:135]
    v_fma_f32 v246, v242, 0.5, 1.0
    v_fma_f32 v247, v243, 0.5, 1.0
    v_mfma_f32_16x16x16_bf16 v[140:143], v[206:207], v[198:199], v[140:143]
    v_fma_f32 v244, v240, v244, 1.0
    v_fma_f32 v245, v241, v245, 1.0
    v_mfma_f32_16x16x16_bf16 v[148:151], v[206:207], v[200:201], v[148:151]
    v_fma_f32 v246, v242, v246, 1.0
    v_fma_f32 v247, v243, v247, 1.0
    v_mfma_f32_16x16x16_bf16 v[156:159], v[206:207], v[202:203], v[156:159]
    v_rcp_f32 v244, v244
    v_rcp_f32 v245, v245
    v_rcp_f32 v246, v246
    v_rcp_f32 v247, v247
    v_fma_f32 v108, -v108, v244, v108
    v_fma_f32 v109, -v109, v245, v109
    v_fma_f32 v110, -v110, v246, v110
    v_fma_f32 v111, -v111, v247, v111
    v_cvt_pk_bf16_f32 v106, v108, v109
    v_cvt_pk_bf16_f32 v107, v110, v111
    v_pk_mul_f32 v[112:113], v[112:113], v[62:63] op_sel_hi:[1,0]
    v_pk_mul_f32 v[114:115], v[114:115], v[62:63] op_sel_hi:[1,0]
    v_exp_f32 v240, v112
    v_exp_f32 v241, v113
    v_exp_f32 v242, v114
    buffer_load_dwordx4 v6, s[64:67], s20 offen offset:2048  lds
    buffer_load_dwordx4 v7, s[64:67], s20 offen offset:3072  lds
    s_waitcnt vmcnt(28)
    ds_read_b64_tr_b16 a[192:193], v20 offset:12288
    ds_read_b64_tr_b16 a[194:195], v20 offset:13312
    ds_read_b64_tr_b16 a[196:197], v20 offset:14336
    ds_read_b64_tr_b16 a[198:199], v20 offset:15360
    v_exp_f32 v243, v115
    v_pk_fma_f32 v[244:245], v[240:241], 0.5, 1.0 op_sel_hi:[1,0,0]
    v_pk_fma_f32 v[246:247], v[242:243], 0.5, 1.0 op_sel_hi:[1,0,0]
    v_pk_fma_f32 v[244:245], v[240:241], v[244:245], 1.0 op_sel_hi:[1,1,0]
    v_pk_fma_f32 v[246:247], v[242:243], v[246:247], 1.0 op_sel_hi:[1,1,0]
    v_rcp_f32 v244, v244
    v_rcp_f32 v245, v245
    v_rcp_f32 v246, v246
    v_rcp_f32 v247, v247
    v_pk_fma_f32 v[112:113], v[112:113], v[244:245], v[112:113] neg_lo:[1,0,0] neg_hi:[1,0,0]
    v_pk_fma_f32 v[114:115], v[114:115], v[246:247], v[114:115] neg_lo:[1,0,0] neg_hi:[1,0,0]
    v_cvt_pk_bf16_f32 v112, v112, v113
    v_cvt_pk_bf16_f32 v113, v114, v115
    v_pk_mul_f32 v[116:117], v[116:117], v[62:63] op_sel_hi:[1,0]
    ds_read_b64_tr_b16 a[200:201], v21 offset:12288
    ds_read_b64_tr_b16 a[202:203], v21 offset:13312
    ds_read_b64_tr_b16 a[204:205], v21 offset:14336
    ds_read_b64_tr_b16 a[206:207], v21 offset:15360
    v_pk_mul_f32 v[118:119], v[118:119], v[62:63] op_sel_hi:[1,0]
    v_exp_f32 v240, v116
    v_exp_f32 v241, v117
    v_exp_f32 v242, v118
    v_exp_f32 v243, v119
    v_pk_fma_f32 v[244:245], v[240:241], 0.5, 1.0 op_sel_hi:[1,0,0]
    v_pk_fma_f32 v[246:247], v[242:243], 0.5, 1.0 op_sel_hi:[1,0,0]
    v_pk_fma_f32 v[244:245], v[240:241], v[244:245], 1.0 op_sel_hi:[1,1,0]
    v_pk_fma_f32 v[246:247], v[242:243], v[246:247], 1.0 op_sel_hi:[1,1,0]
    v_rcp_f32 v244, v244
    v_rcp_f32 v245, v245
    v_rcp_f32 v246, v246
    v_rcp_f32 v247, v247
    v_pk_fma_f32 v[116:117], v[116:117], v[244:245], v[116:117] neg_lo:[1,0,0] neg_hi:[1,0,0]
    s_add_u32 m0, s6, 12288
    s_add_u32 s7, s17, s0
    s_waitcnt lgkmcnt(0)
    buffer_load_dwordx4 v12, s[72:75], s7 offen offset:0  lds
    buffer_load_dwordx4 v13, s[72:75], s7 offen offset:1024  lds
    s_waitcnt vmcnt(26)
    s_nop 0
    ds_read_b64_tr_b16 a[208:209], v20 offset:16384
    ds_read_b64_tr_b16 a[210:211], v20 offset:17408
    ds_read_b64_tr_b16 a[212:213], v20 offset:18432
    ds_read_b64_tr_b16 a[214:215], v20 offset:19456
    v_pk_fma_f32 v[118:119], v[118:119], v[246:247], v[118:119] neg_lo:[1,0,0] neg_hi:[1,0,0]
    v_cvt_pk_bf16_f32 v114, v116, v117
    v_cvt_pk_bf16_f32 v115, v118, v119
    v_pk_mul_f32 v[120:121], v[120:121], v[62:63] op_sel:[0,1] op_sel_hi:[1,1]
    v_pk_mul_f32 v[122:123], v[122:123], v[62:63] op_sel:[0,1] op_sel_hi:[1,1]
    v_exp_f32 v240, v120
    v_exp_f32 v241, v121
    v_exp_f32 v242, v122
    v_exp_f32 v243, v123
    v_pk_fma_f32 v[244:245], v[240:241], 0.5, 1.0 op_sel_hi:[1,0,0]
    v_pk_fma_f32 v[246:247], v[242:243], 0.5, 1.0 op_sel_hi:[1,0,0]
    v_pk_fma_f32 v[244:245], v[240:241], v[244:245], 1.0 op_sel_hi:[1,1,0]
    v_pk_fma_f32 v[246:247], v[242:243], v[246:247], 1.0 op_sel_hi:[1,1,0]
    v_rcp_f32 v244, v244
    buffer_load_dwordx4 v14, s[72:75], s7 offen offset:2048  lds
    buffer_load_dwordx4 v15, s[72:75], s7 offen offset:3072  lds
    ds_read_b64_tr_b16 a[216:217], v21 offset:16384
    ds_read_b64_tr_b16 a[218:219], v21 offset:17408
    ds_read_b64_tr_b16 a[220:221], v21 offset:18432
    ds_read_b64_tr_b16 a[222:223], v21 offset:19456
    v_rcp_f32 v245, v245
    v_rcp_f32 v246, v246
    v_rcp_f32 v247, v247
    v_pk_fma_f32 v[120:121], v[120:121], v[244:245], v[120:121] neg_lo:[1,0,0] neg_hi:[1,0,0]
    v_pk_fma_f32 v[122:123], v[122:123], v[246:247], v[122:123] neg_lo:[1,0,0] neg_hi:[1,0,0]
    v_cvt_pk_bf16_f32 v120, v120, v121
    v_cvt_pk_bf16_f32 v121, v122, v123
    v_pk_mul_f32 v[124:125], v[124:125], v[62:63] op_sel:[0,1] op_sel_hi:[1,1]
    v_pk_mul_f32 v[126:127], v[126:127], v[62:63] op_sel:[0,1] op_sel_hi:[1,1]
    v_exp_f32 v240, v124
    v_exp_f32 v241, v125
    v_exp_f32 v242, v126
    v_exp_f32 v243, v127
    v_pk_fma_f32 v[244:245], v[240:241], 0.5, 1.0 op_sel_hi:[1,0,0]
    s_add_u32 m0, s6, 16384
    s_add_u32 s7, s17, s1
    s_waitcnt lgkmcnt(0)
    buffer_load_dwordx4 v12, s[72:75], s7 offen offset:0  lds
    buffer_load_dwordx4 v13, s[72:75], s7 offen offset:1024  lds
    s_waitcnt vmcnt(26)
    ds_read_b64_tr_b16 a[224:225], v20 offset:20480
    ds_read_b64_tr_b16 a[226:227], v20 offset:21504
    ds_read_b64_tr_b16 a[228:229], v20 offset:22528
    ds_read_b64_tr_b16 a[230:231], v20 offset:23552
    v_pk_fma_f32 v[246:247], v[242:243], 0.5, 1.0 op_sel_hi:[1,0,0]
    v_pk_fma_f32 v[244:245], v[240:241], v[244:245], 1.0 op_sel_hi:[1,1,0]
    v_pk_fma_f32 v[246:247], v[242:243], v[246:247], 1.0 op_sel_hi:[1,1,0]
    v_rcp_f32 v244, v244
    v_rcp_f32 v245, v245
    v_rcp_f32 v246, v246
    v_rcp_f32 v247, v247
    v_pk_fma_f32 v[124:125], v[124:125], v[244:245], v[124:125] neg_lo:[1,0,0] neg_hi:[1,0,0]
    v_pk_fma_f32 v[126:127], v[126:127], v[246:247], v[126:127] neg_lo:[1,0,0] neg_hi:[1,0,0]
    v_cvt_pk_bf16_f32 v122, v124, v125
    v_cvt_pk_bf16_f32 v123, v126, v127
    v_pk_mul_f32 v[128:129], v[128:129], v[60:61] op_sel_hi:[1,0]
    v_pk_mul_f32 v[130:131], v[130:131], v[60:61] op_sel_hi:[1,0]
    v_exp_f32 v240, v128
    buffer_load_dwordx4 v14, s[72:75], s7 offen offset:2048  lds
    buffer_load_dwordx4 v15, s[72:75], s7 offen offset:3072  lds
    ds_read_b64_tr_b16 a[232:233], v21 offset:20480
    ds_read_b64_tr_b16 a[234:235], v21 offset:21504
    ds_read_b64_tr_b16 a[236:237], v21 offset:22528
    ds_read_b64_tr_b16 a[238:239], v21 offset:23552
    v_exp_f32 v241, v129
    v_exp_f32 v242, v130
    v_exp_f32 v243, v131
    v_pk_fma_f32 v[244:245], v[240:241], 0.5, 1.0 op_sel_hi:[1,0,0]
    v_pk_fma_f32 v[246:247], v[242:243], 0.5, 1.0 op_sel_hi:[1,0,0]
    v_pk_fma_f32 v[244:245], v[240:241], v[244:245], 1.0 op_sel_hi:[1,1,0]
    v_pk_fma_f32 v[246:247], v[242:243], v[246:247], 1.0 op_sel_hi:[1,1,0]
    v_rcp_f32 v244, v244
    v_rcp_f32 v245, v245
    v_rcp_f32 v246, v246
    v_rcp_f32 v247, v247
    v_pk_fma_f32 v[128:129], v[128:129], v[244:245], v[128:129] neg_lo:[1,0,0] neg_hi:[1,0,0]
    v_pk_fma_f32 v[130:131], v[130:131], v[246:247], v[130:131] neg_lo:[1,0,0] neg_hi:[1,0,0]
    v_cvt_pk_bf16_f32 v128, v128, v129
    s_add_u32 m0, s6, 20480
    s_add_u32 s7, s17, s56
    s_waitcnt lgkmcnt(0)
    buffer_load_dwordx4 v12, s[72:75], s7 offen offset:0  lds
    buffer_load_dwordx4 v13, s[72:75], s7 offen offset:1024  lds
    s_waitcnt vmcnt(26)
    ds_read_b64_tr_b16 a[240:241], v20 offset:0
    ds_read_b64_tr_b16 a[242:243], v20 offset:1024
    ds_read_b64_tr_b16 a[244:245], v20 offset:2048
    ds_read_b64_tr_b16 a[246:247], v20 offset:3072
    v_cvt_pk_bf16_f32 v129, v130, v131
    v_pk_mul_f32 v[132:133], v[132:133], v[60:61] op_sel_hi:[1,0]
    v_pk_mul_f32 v[134:135], v[134:135], v[60:61] op_sel_hi:[1,0]
    v_exp_f32 v240, v132
    v_exp_f32 v241, v133
    v_exp_f32 v242, v134
    v_exp_f32 v243, v135
    v_pk_fma_f32 v[244:245], v[240:241], 0.5, 1.0 op_sel_hi:[1,0,0]
    v_pk_fma_f32 v[246:247], v[242:243], 0.5, 1.0 op_sel_hi:[1,0,0]
    v_pk_fma_f32 v[244:245], v[240:241], v[244:245], 1.0 op_sel_hi:[1,1,0]
    v_pk_fma_f32 v[246:247], v[242:243], v[246:247], 1.0 op_sel_hi:[1,1,0]
    v_rcp_f32 v244, v244
    v_rcp_f32 v245, v245
    v_rcp_f32 v246, v246
    buffer_load_dwordx4 v14, s[72:75], s7 offen offset:2048  lds
    buffer_load_dwordx4 v15, s[72:75], s7 offen offset:3072  lds
    ds_read_b64_tr_b16 a[248:249], v21 offset:0
    ds_read_b64_tr_b16 a[250:251], v21 offset:1024
    ds_read_b64_tr_b16 a[252:253], v21 offset:2048
    ds_read_b64_tr_b16 a[254:255], v21 offset:3072
    v_rcp_f32 v247, v247
    v_pk_fma_f32 v[132:133], v[132:133], v[244:245], v[132:133] neg_lo:[1,0,0] neg_hi:[1,0,0]
    v_pk_fma_f32 v[134:135], v[134:135], v[246:247], v[134:135] neg_lo:[1,0,0] neg_hi:[1,0,0]
    v_cvt_pk_bf16_f32 v130, v132, v133
    v_cvt_pk_bf16_f32 v131, v134, v135
    v_pk_mul_f32 v[136:137], v[136:137], v[60:61] op_sel:[0,1] op_sel_hi:[1,1]
    v_pk_mul_f32 v[138:139], v[138:139], v[60:61] op_sel:[0,1] op_sel_hi:[1,1]
    v_exp_f32 v240, v136
    v_exp_f32 v241, v137
    v_exp_f32 v242, v138
    v_exp_f32 v243, v139
    v_pk_fma_f32 v[244:245], v[240:241], 0.5, 1.0 op_sel_hi:[1,0,0]
    v_pk_fma_f32 v[246:247], v[242:243], 0.5, 1.0 op_sel_hi:[1,0,0]
    v_pk_fma_f32 v[244:245], v[240:241], v[244:245], 1.0 op_sel_hi:[1,1,0]
    s_add_u32 m0, s6, 0
    s_add_u32 s7, s17, s57
    s_waitcnt lgkmcnt(0)
    buffer_load_dwordx4 v12, s[72:75], s7 offen offset:0  lds
    buffer_load_dwordx4 v13, s[72:75], s7 offen offset:1024  lds
    s_waitcnt vmcnt(28)
    ds_read_b128 v[192:195], v16 offset:4096
    ds_read_b128 v[196:199], v17 offset:4096
    v_pk_fma_f32 v[246:247], v[242:243], v[246:247], 1.0 op_sel_hi:[1,1,0]
    v_rcp_f32 v244, v244
    v_rcp_f32 v245, v245
    v_rcp_f32 v246, v246
    v_rcp_f32 v247, v247
    v_pk_fma_f32 v[136:137], v[136:137], v[244:245], v[136:137] neg_lo:[1,0,0] neg_hi:[1,0,0]
    v_pk_fma_f32 v[138:139], v[138:139], v[246:247], v[138:139] neg_lo:[1,0,0] neg_hi:[1,0,0]
    v_cvt_pk_bf16_f32 v136, v136, v137
    v_cvt_pk_bf16_f32 v137, v138, v139
    v_pk_mul_f32 v[140:141], v[140:141], v[60:61] op_sel:[0,1] op_sel_hi:[1,1]
    v_pk_mul_f32 v[142:143], v[142:143], v[60:61] op_sel:[0,1] op_sel_hi:[1,1]
    v_exp_f32 v240, v140
    v_exp_f32 v241, v141
    v_exp_f32 v242, v142
    buffer_load_dwordx4 v14, s[72:75], s7 offen offset:2048  lds
    buffer_load_dwordx4 v15, s[72:75], s7 offen offset:3072  lds
    s_waitcnt vmcnt(28)
    ds_read_b128 v[200:203], v16 offset:6144
    ds_read_b128 v[204:207], v17 offset:6144
    v_exp_f32 v243, v143
    v_pk_fma_f32 v[244:245], v[240:241], 0.5, 1.0 op_sel_hi:[1,0,0]
    v_pk_fma_f32 v[246:247], v[242:243], 0.5, 1.0 op_sel_hi:[1,0,0]
    v_pk_fma_f32 v[244:245], v[240:241], v[244:245], 1.0 op_sel_hi:[1,1,0]
    v_pk_fma_f32 v[246:247], v[242:243], v[246:247], 1.0 op_sel_hi:[1,1,0]
    v_rcp_f32 v244, v244
    v_rcp_f32 v245, v245
    v_rcp_f32 v246, v246
    v_rcp_f32 v247, v247
    v_pk_fma_f32 v[140:141], v[140:141], v[244:245], v[140:141] neg_lo:[1,0,0] neg_hi:[1,0,0]
    v_pk_fma_f32 v[142:143], v[142:143], v[246:247], v[142:143] neg_lo:[1,0,0] neg_hi:[1,0,0]
    v_cvt_pk_bf16_f32 v138, v140, v141
    v_cvt_pk_bf16_f32 v139, v142, v143
    v_pk_mul_f32 v[144:145], v[144:145], v[62:63] op_sel_hi:[1,0]
    s_add_u32 m0, s6, 4096
    s_waitcnt lgkmcnt(2)
    buffer_load_dwordx4 v4, s[60:63], s21 offen offset:0  lds
    buffer_load_dwordx4 v5, s[60:63], s21 offen offset:1024  lds
    v_pk_mul_f32 v[146:147], v[146:147], v[62:63] op_sel_hi:[1,0]
    v_exp_f32 v240, v144
    v_exp_f32 v241, v145
    v_exp_f32 v242, v146
    v_exp_f32 v243, v147
    v_pk_fma_f32 v[244:245], v[240:241], 0.5, 1.0 op_sel_hi:[1,0,0]
    v_pk_fma_f32 v[246:247], v[242:243], 0.5, 1.0 op_sel_hi:[1,0,0]
    v_pk_fma_f32 v[244:245], v[240:241], v[244:245], 1.0 op_sel_hi:[1,1,0]
    v_pk_fma_f32 v[246:247], v[242:243], v[246:247], 1.0 op_sel_hi:[1,1,0]
    v_rcp_f32 v244, v244
    v_rcp_f32 v245, v245
    v_rcp_f32 v246, v246
    v_rcp_f32 v247, v247
    v_pk_fma_f32 v[144:145], v[144:145], v[244:245], v[144:145] neg_lo:[1,0,0] neg_hi:[1,0,0]
    s_waitcnt lgkmcnt(0)
    buffer_load_dwordx4 v6, s[60:63], s21 offen offset:2048  lds
    buffer_load_dwordx4 v7, s[60:63], s21 offen offset:3072  lds
    v_pk_fma_f32 v[146:147], v[146:147], v[246:247], v[146:147] neg_lo:[1,0,0] neg_hi:[1,0,0]
    v_cvt_pk_bf16_f32 v144, v144, v145
    v_cvt_pk_bf16_f32 v145, v146, v147
    v_pk_mul_f32 v[148:149], v[148:149], v[62:63] op_sel_hi:[1,0]
    v_pk_mul_f32 v[150:151], v[150:151], v[62:63] op_sel_hi:[1,0]
    v_exp_f32 v240, v148
    v_exp_f32 v241, v149
    v_exp_f32 v242, v150
    v_exp_f32 v243, v151
    v_pk_fma_f32 v[244:245], v[240:241], 0.5, 1.0 op_sel_hi:[1,0,0]
    v_pk_fma_f32 v[246:247], v[242:243], 0.5, 1.0 op_sel_hi:[1,0,0]
    v_pk_fma_f32 v[244:245], v[240:241], v[244:245], 1.0 op_sel_hi:[1,1,0]
    v_pk_fma_f32 v[246:247], v[242:243], v[246:247], 1.0 op_sel_hi:[1,1,0]
    v_rcp_f32 v244, v244
    v_rcp_f32 v245, v245
    v_rcp_f32 v246, v246
    v_rcp_f32 v247, v247
    v_pk_fma_f32 v[148:149], v[148:149], v[244:245], v[148:149] neg_lo:[1,0,0] neg_hi:[1,0,0]
    v_pk_fma_f32 v[150:151], v[150:151], v[246:247], v[150:151] neg_lo:[1,0,0] neg_hi:[1,0,0]
    s_waitcnt vmcnt(28)
    v_max3_u32 v248, v224, v225, v226
    s_waitcnt vmcnt(27)
    v_max3_u32 v248, v248, v227, v228
    s_waitcnt vmcnt(26)
    v_max3_u32 v248, v248, v229, v230
    s_waitcnt vmcnt(25)
    v_max3_u32 v248, v248, v231, v232
    s_waitcnt vmcnt(24)
    v_max3_u32 v248, v248, v233, v234
    s_waitcnt vmcnt(23)
    v_max3_u32 v248, v248, v235, v236
    s_waitcnt vmcnt(22)
    v_max3_u32 v248, v248, v237, v238
    v_max_u32 v248, v248, v239
    v_cmp_eq_u32 vcc, -1, v248
    s_nop 0
    s_cbranch_vccnz L_carry_spin
L_carry_ok:
    v_pk_fma_f32 v[236:237], v[238:239], v[54:55], v[236:237] op_sel_hi:[1,0,1]
    v_pk_fma_f32 v[236:237], v[238:239], v[54:55], v[236:237] op_sel:[1,1,0] op_sel_hi:[0,1,1] neg_lo:[1,0,0]
    v_cvt_pk_bf16_f32 v146, v148, v149
    v_cvt_pk_bf16_f32 v147, v150, v151
    v_pk_fma_f32 v[234:235], v[236:237], v[54:55], v[234:235] op_sel_hi:[1,0,1]
    v_pk_fma_f32 v[234:235], v[236:237], v[54:55], v[234:235] op_sel:[1,1,0] op_sel_hi:[0,1,1] neg_lo:[1,0,0]
    v_pk_mul_f32 v[152:153], v[152:153], v[62:63] op_sel:[0,1] op_sel_hi:[1,1]
    v_pk_mul_f32 v[154:155], v[154:155], v[62:63] op_sel:[0,1] op_sel_hi:[1,1]
    v_pk_fma_f32 v[232:233], v[234:235], v[54:55], v[232:233] op_sel_hi:[1,0,1]
    v_pk_fma_f32 v[232:233], v[234:235], v[54:55], v[232:233] op_sel:[1,1,0] op_sel_hi:[0,1,1] neg_lo:[1,0,0]
    v_exp_f32 v240, v152
    v_exp_f32 v241, v153
    v_pk_fma_f32 v[230:231], v[232:233], v[54:55], v[230:231] op_sel_hi:[1,0,1]
    v_pk_fma_f32 v[230:231], v[232:233], v[54:55], v[230:231] op_sel:[1,1,0] op_sel_hi:[0,1,1] neg_lo:[1,0,0]
    v_exp_f32 v242, v154
    v_exp_f32 v243, v155
    v_pk_fma_f32 v[228:229], v[230:231], v[54:55], v[228:229] op_sel_hi:[1,0,1]
    v_pk_fma_f32 v[228:229], v[230:231], v[54:55], v[228:229] op_sel:[1,1,0] op_sel_hi:[0,1,1] neg_lo:[1,0,0]
    v_pk_fma_f32 v[244:245], v[240:241], 0.5, 1.0 op_sel_hi:[1,0,0]
    v_pk_fma_f32 v[246:247], v[242:243], 0.5, 1.0 op_sel_hi:[1,0,0]
    v_pk_fma_f32 v[226:227], v[228:229], v[54:55], v[226:227] op_sel_hi:[1,0,1]
    v_pk_fma_f32 v[226:227], v[228:229], v[54:55], v[226:227] op_sel:[1,1,0] op_sel_hi:[0,1,1] neg_lo:[1,0,0]
    v_pk_fma_f32 v[244:245], v[240:241], v[244:245], 1.0 op_sel_hi:[1,1,0]
    v_pk_fma_f32 v[246:247], v[242:243], v[246:247], 1.0 op_sel_hi:[1,1,0]
    v_pk_fma_f32 v[224:225], v[226:227], v[54:55], v[224:225] op_sel_hi:[1,0,1]
    v_pk_fma_f32 v[224:225], v[226:227], v[54:55], v[224:225] op_sel:[1,1,0] op_sel_hi:[0,1,1] neg_lo:[1,0,0]
    v_rcp_f32 v244, v244
    v_rcp_f32 v245, v245
    v_mov_b32 v226, v224
    v_mov_b32 v227, v225
    v_rcp_f32 v246, v246
    v_rcp_f32 v247, v247
    v_permlane16_swap_b32 v224, v226
    v_permlane16_swap_b32 v225, v227
    v_pk_fma_f32 v[152:153], v[152:153], v[244:245], v[152:153] neg_lo:[1,0,0] neg_hi:[1,0,0]
    v_pk_fma_f32 v[154:155], v[154:155], v[246:247], v[154:155] neg_lo:[1,0,0] neg_hi:[1,0,0]
    v_pk_fma_f32 v[224:225], v[226:227], v[56:57], v[224:225] op_sel_hi:[1,0,1]
    v_pk_fma_f32 v[224:225], v[226:227], v[56:57], v[224:225] op_sel:[1,1,0] op_sel_hi:[0,1,1] neg_lo:[1,0,0]
    v_cvt_pk_bf16_f32 v152, v152, v153
    v_cvt_pk_bf16_f32 v153, v154, v155
    v_mov_b32 v226, v224
    v_mov_b32 v227, v225
    v_pk_mul_f32 v[156:157], v[156:157], v[62:63] op_sel:[0,1] op_sel_hi:[1,1]
    v_pk_mul_f32 v[158:159], v[158:159], v[62:63] op_sel:[0,1] op_sel_hi:[1,1]
    v_permlane32_swap_b32 v224, v226
    v_permlane32_swap_b32 v225, v227
    v_exp_f32 v240, v156
    v_exp_f32 v241, v157
    v_pk_fma_f32 v[224:225], v[226:227], v[58:59], v[224:225] op_sel_hi:[1,0,1]
    v_pk_fma_f32 v[224:225], v[226:227], v[58:59], v[224:225] op_sel:[1,1,0] op_sel_hi:[0,1,1] neg_lo:[1,0,0]
    v_exp_f32 v242, v158
    v_exp_f32 v243, v159
    v_pk_fma_f32 v[220:221], v[224:225], v[52:53], v[220:221] op_sel_hi:[1,0,1]
    v_pk_fma_f32 v[220:221], v[224:225], v[52:53], v[220:221] op_sel:[1,1,0] op_sel_hi:[0,1,1] neg_lo:[1,0,0]
    v_pk_fma_f32 v[244:245], v[240:241], 0.5, 1.0 op_sel_hi:[1,0,0]
    v_pk_fma_f32 v[246:247], v[242:243], 0.5, 1.0 op_sel_hi:[1,0,0]
    v_mov_b32_dpp v224, v220 quad_perm:[0,1,2,3] row_mask:0xc bank_mask:0xf
    v_mov_b32_dpp v225, v221 quad_perm:[0,1,2,3] row_mask:0xc bank_mask:0xf
    v_pk_fma_f32 v[244:245], v[240:241], v[244:245], 1.0 op_sel_hi:[1,1,0]
    v_pk_fma_f32 v[246:247], v[242:243], v[246:247], 1.0 op_sel_hi:[1,1,0]
    v_pk_fma_f32 v[218:219], v[224:225], v[50:51], v[218:219] op_sel_hi:[1,0,1]
    v_pk_fma_f32 v[218:219], v[224:225], v[50:51], v[218:219] op_sel:[1,1,0] op_sel_hi:[0,1,1] neg_lo:[1,0,0]
    v_rcp_f32 v244, v244
    v_rcp_f32 v245, v245
    v_mov_b32_dpp v224, v218 quad_perm:[0,1,2,3] row_mask:0xa bank_mask:0xf
    v_mov_b32_dpp v225, v219 quad_perm:[0,1,2,3] row_mask:0xa bank_mask:0xf
    v_rcp_f32 v246, v246
    v_rcp_f32 v247, v247
    v_pk_fma_f32 v[216:217], v[224:225], v[48:49], v[216:217] op_sel_hi:[1,0,1]
    v_pk_fma_f32 v[216:217], v[224:225], v[48:49], v[216:217] op_sel:[1,1,0] op_sel_hi:[0,1,1] neg_lo:[1,0,0]
    v_pk_fma_f32 v[156:157], v[156:157], v[244:245], v[156:157] neg_lo:[1,0,0] neg_hi:[1,0,0]
    v_pk_fma_f32 v[158:159], v[158:159], v[246:247], v[158:159] neg_lo:[1,0,0] neg_hi:[1,0,0]
    v_pk_mov_b32 v[228:229], v[224:225], v[216:217] op_sel:[0,0]
    v_pk_mov_b32 v[230:231], v[224:225], v[216:217] op_sel:[1,1]
    v_cvt_pk_bf16_f32 v154, v156, v157
    v_cvt_pk_bf16_f32 v155, v158, v159
    v_pk_fma_f32 v[64:65], v[228:229], v[44:45], v[64:65] op_sel_hi:[1,0,1]
    v_pk_fma_f32 v[80:81], v[230:231], v[44:45], v[80:81] op_sel_hi:[1,0,1]
    v_pk_fma_f32 v[64:65], v[230:231], v[44:45], v[64:65] op_sel:[0,1,0] op_sel_hi:[1,1,1] neg_lo:[1,0,0] neg_hi:[1,0,0]
    v_pk_fma_f32 v[80:81], v[228:229], v[44:45], v[80:81] op_sel:[0,1,0] op_sel_hi:[1,1,1]
    v_pk_fma_f32 v[66:67], v[64:65], v[44:45], v[66:67] op_sel_hi:[1,0,1]
    v_pk_fma_f32 v[82:83], v[80:81], v[44:45], v[82:83] op_sel_hi:[1,0,1]
    v_pk_mul_f32 v[240:241], v[64:65], v[46:47] op_sel_hi:[1,0]
    v_pk_mul_f32 v[242:243], v[80:81], v[46:47] op_sel_hi:[1,0]
    v_pk_fma_f32 v[66:67], v[80:81], v[44:45], v[66:67] op_sel:[0,1,0] op_sel_hi:[1,1,1] neg_lo:[1,0,0] neg_hi:[1,0,0]
    ds_write_b128 v26, v[96:99] offset:0
    v_pk_fma_f32 v[82:83], v[64:65], v[44:45], v[82:83] op_sel:[0,1,0] op_sel_hi:[1,1,1]
    v_pk_fma_f32 v[240:241], v[80:81], v[46:47], v[240:241] op_sel:[0,1,0] op_sel_hi:[1,1,1] neg_lo:[1,0,0] neg_hi:[1,0,0]
    v_pk_fma_f32 v[242:243], v[64:65], v[46:47], v[242:243] op_sel:[0,1,0] op_sel_hi:[1,1,1]
    v_cvt_pk_bf16_f32 v176, v240, v241
    v_cvt_pk_bf16_f32 v184, -v242, -v243
    v_pk_fma_f32 v[68:69], v[66:67], v[44:45], v[68:69] op_sel_hi:[1,0,1]
    v_pk_fma_f32 v[84:85], v[82:83], v[44:45], v[84:85] op_sel_hi:[1,0,1]
    v_pk_mul_f32 v[244:245], v[66:67], v[46:47] op_sel_hi:[1,0]
    v_pk_mul_f32 v[246:247], v[82:83], v[46:47] op_sel_hi:[1,0]
    ds_write_b128 v26, v[104:107] offset:1024
    v_pk_fma_f32 v[68:69], v[82:83], v[44:45], v[68:69] op_sel:[0,1,0] op_sel_hi:[1,1,1] neg_lo:[1,0,0] neg_hi:[1,0,0]
    v_pk_fma_f32 v[84:85], v[66:67], v[44:45], v[84:85] op_sel:[0,1,0] op_sel_hi:[1,1,1]
    v_pk_fma_f32 v[244:245], v[82:83], v[46:47], v[244:245] op_sel:[0,1,0] op_sel_hi:[1,1,1] neg_lo:[1,0,0] neg_hi:[1,0,0]
    v_pk_fma_f32 v[246:247], v[66:67], v[46:47], v[246:247] op_sel:[0,1,0] op_sel_hi:[1,1,1]
    v_cvt_pk_bf16_f32 v177, v244, v245
    v_cvt_pk_bf16_f32 v185, -v246, -v247
    v_pk_fma_f32 v[70:71], v[68:69], v[44:45], v[70:71] op_sel_hi:[1,0,1]
    v_pk_fma_f32 v[86:87], v[84:85], v[44:45], v[86:87] op_sel_hi:[1,0,1]
    v_pk_mul_f32 v[240:241], v[68:69], v[46:47] op_sel_hi:[1,0]
    ds_write_b128 v26, v[112:115] offset:2048
    v_pk_mul_f32 v[242:243], v[84:85], v[46:47] op_sel_hi:[1,0]
    v_pk_fma_f32 v[70:71], v[84:85], v[44:45], v[70:71] op_sel:[0,1,0] op_sel_hi:[1,1,1] neg_lo:[1,0,0] neg_hi:[1,0,0]
    v_pk_fma_f32 v[86:87], v[68:69], v[44:45], v[86:87] op_sel:[0,1,0] op_sel_hi:[1,1,1]
    v_pk_fma_f32 v[240:241], v[84:85], v[46:47], v[240:241] op_sel:[0,1,0] op_sel_hi:[1,1,1] neg_lo:[1,0,0] neg_hi:[1,0,0]
    v_pk_fma_f32 v[242:243], v[68:69], v[46:47], v[242:243] op_sel:[0,1,0] op_sel_hi:[1,1,1]
    v_cvt_pk_bf16_f32 v178, v240, v241
    v_cvt_pk_bf16_f32 v186, -v242, -v243
    v_pk_fma_f32 v[72:73], v[70:71], v[44:45], v[72:73] op_sel_hi:[1,0,1]
    v_pk_fma_f32 v[88:89], v[86:87], v[44:45], v[88:89] op_sel_hi:[1,0,1]
    ds_write_b128 v26, v[120:123] offset:3072
    v_pk_mul_f32 v[244:245], v[70:71], v[46:47] op_sel_hi:[1,0]
    v_pk_mul_f32 v[246:247], v[86:87], v[46:47] op_sel_hi:[1,0]
    v_pk_fma_f32 v[72:73], v[86:87], v[44:45], v[72:73] op_sel:[0,1,0] op_sel_hi:[1,1,1] neg_lo:[1,0,0] neg_hi:[1,0,0]
    v_pk_fma_f32 v[88:89], v[70:71], v[44:45], v[88:89] op_sel:[0,1,0] op_sel_hi:[1,1,1]
    v_pk_fma_f32 v[244:245], v[86:87], v[46:47], v[244:245] op_sel:[0,1,0] op_sel_hi:[1,1,1] neg_lo:[1,0,0] neg_hi:[1,0,0]
    v_pk_fma_f32 v[246:247], v[70:71], v[46:47], v[246:247] op_sel:[0,1,0] op_sel_hi:[1,1,1]
    v_cvt_pk_bf16_f32 v179, v244, v245
    v_cvt_pk_bf16_f32 v187, -v246, -v247
    v_pk_fma_f32 v[74:75], v[72:73], v[44:45], v[74:75] op_sel_hi:[1,0,1]
    ds_write_b128 v27, v[128:131] offset:0
    v_pk_fma_f32 v[90:91], v[88:89], v[44:45], v[90:91] op_sel_hi:[1,0,1]
    v_pk_mul_f32 v[240:241], v[72:73], v[46:47] op_sel_hi:[1,0]
    v_pk_mul_f32 v[242:243], v[88:89], v[46:47] op_sel_hi:[1,0]
    v_pk_fma_f32 v[74:75], v[88:89], v[44:45], v[74:75] op_sel:[0,1,0] op_sel_hi:[1,1,1] neg_lo:[1,0,0] neg_hi:[1,0,0]
    v_pk_fma_f32 v[90:91], v[72:73], v[44:45], v[90:91] op_sel:[0,1,0] op_sel_hi:[1,1,1]
    v_pk_fma_f32 v[240:241], v[88:89], v[46:47], v[240:241] op_sel:[0,1,0] op_sel_hi:[1,1,1] neg_lo:[1,0,0] neg_hi:[1,0,0]
    v_pk_fma_f32 v[242:243], v[72:73], v[46:47], v[242:243] op_sel:[0,1,0] op_sel_hi:[1,1,1]
    v_cvt_pk_bf16_f32 v180, v240, v241
    v_cvt_pk_bf16_f32 v188, -v242, -v243
    ds_write_b128 v27, v[136:139] offset:1024
    v_pk_fma_f32 v[76:77], v[74:75], v[44:45], v[76:77] op_sel_hi:[1,0,1]
    v_pk_fma_f32 v[92:93], v[90:91], v[44:45], v[92:93] op_sel_hi:[1,0,1]
    v_pk_mul_f32 v[244:245], v[74:75], v[46:47] op_sel_hi:[1,0]
    v_pk_mul_f32 v[246:247], v[90:91], v[46:47] op_sel_hi:[1,0]
    v_pk_fma_f32 v[76:77], v[90:91], v[44:45], v[76:77] op_sel:[0,1,0] op_sel_hi:[1,1,1] neg_lo:[1,0,0] neg_hi:[1,0,0]
    v_pk_fma_f32 v[92:93], v[74:75], v[44:45], v[92:93] op_sel:[0,1,0] op_sel_hi:[1,1,1]
    v_pk_fma_f32 v[244:245], v[90:91], v[46:47], v[244:245] op_sel:[0,1,0] op_sel_hi:[1,1,1] neg_lo:[1,0,0] neg_hi:[1,0,0]
    v_pk_fma_f32 v[246:247], v[74:75], v[46:47], v[246:247] op_sel:[0,1,0] op_sel_hi:[1,1,1]
    v_cvt_pk_bf16_f32 v181, v244, v245
    ds_write_b128 v27, v[144:147] offset:2048
    v_cvt_pk_bf16_f32 v189, -v246, -v247
    v_pk_fma_f32 v[78:79], v[76:77], v[44:45], v[78:79] op_sel_hi:[1,0,1]
    v_pk_fma_f32 v[94:95], v[92:93], v[44:45], v[94:95] op_sel_hi:[1,0,1]
    v_pk_mul_f32 v[240:241], v[76:77], v[46:47] op_sel_hi:[1,0]
    v_pk_mul_f32 v[242:243], v[92:93], v[46:47] op_sel_hi:[1,0]
    v_pk_fma_f32 v[78:79], v[92:93], v[44:45], v[78:79] op_sel:[0,1,0] op_sel_hi:[1,1,1] neg_lo:[1,0,0] neg_hi:[1,0,0]
    v_pk_fma_f32 v[94:95], v[76:77], v[44:45], v[94:95] op_sel:[0,1,0] op_sel_hi:[1,1,1]
    v_pk_fma_f32 v[240:241], v[92:93], v[46:47], v[240:241] op_sel:[0,1,0] op_sel_hi:[1,1,1] neg_lo:[1,0,0] neg_hi:[1,0,0]
    v_pk_fma_f32 v[242:243], v[76:77], v[46:47], v[242:243] op_sel:[0,1,0] op_sel_hi:[1,1,1]
    ds_write_b128 v27, v[152:155] offset:3072
    v_cvt_pk_bf16_f32 v182, v240, v241
    v_cvt_pk_bf16_f32 v190, -v242, -v243
    v_pk_mul_f32 v[244:245], v[78:79], v[46:47] op_sel_hi:[1,0]
    v_pk_mul_f32 v[246:247], v[94:95], v[46:47] op_sel_hi:[1,0]
    v_pk_fma_f32 v[244:245], v[94:95], v[46:47], v[244:245] op_sel:[0,1,0] op_sel_hi:[1,1,1] neg_lo:[1,0,0] neg_hi:[1,0,0]
    v_pk_fma_f32 v[246:247], v[78:79], v[46:47], v[246:247] op_sel:[0,1,0] op_sel_hi:[1,1,1]
    v_cvt_pk_bf16_f32 v183, v244, v245
    v_cvt_pk_bf16_f32 v191, -v246, -v247
    ds_write_b64 v28, v[176:177] offset:32768
    ds_write_b64 v29, v[178:179] offset:32768
    ds_write_b64 v30, v[180:181] offset:32768
    ds_write_b64 v31, v[182:183] offset:32768
    ds_write_b64 v28, v[184:185] offset:40960
    ds_write_b64 v29, v[186:187] offset:40960
    ds_write_b64 v30, v[188:189] offset:40960
    ds_write_b64 v31, v[190:191] offset:40960
    s_waitcnt lgkmcnt(0)
    s_barrier
    ds_read_b128 a[0:3], v24 offset:0
    ds_read_b128 a[4:7], v24 offset:4096
    ds_read_b128 a[8:11], v24 offset:1024
    ds_read_b128 a[12:15], v24 offset:5120
    ds_read_b128 a[16:19], v25 offset:0
    ds_read_b128 a[20:23], v25 offset:4096
    ds_read_b128 a[24:27], v25 offset:1024
    ds_read_b128 a[28:31], v25 offset:5120
    s_waitcnt vmcnt(20) lgkmcnt(0)
    v_mfma_f32_16x16x32_bf16 v[96:99], a[0:3], a[192:195], 0
    ds_read_b128 a[32:35], v24 offset:8192
    ds_read_b128 a[36:39], v24 offset:12288
    v_mfma_f32_16x16x32_bf16 v[96:99], a[4:7], a[196:199], v[96:99]
    s_mov_b32 s30, 0x3f317218
    s_mov_b32 s8, 0x00003f80
    v_mfma_f32_16x16x32_bf16 v[104:107], a[8:11], a[192:195], 0
    ds_read_b128 a[40:43], v24 offset:9216
    ds_read_b128 a[44:47], v24 offset:13312
    v_mfma_f32_16x16x32_bf16 v[104:107], a[12:15], a[196:199], v[104:107]
    s_mov_b32 s9, 0x3f800000
    s_lshl_b32 s12, s27, 10
    v_mfma_f32_16x16x32_bf16 v[112:115], a[16:19], a[192:195], 0
    ds_read_b128 v[224:227], v16 offset:8192
    ds_read_b128 v[228:231], v17 offset:8192
    v_mfma_f32_16x16x32_bf16 v[112:115], a[20:23], a[196:199], v[112:115]
    s_add_u32 s12, s12, 1048576
    s_lshl4_add_u32 s27, s27, 114688
    v_mfma_f32_16x16x32_bf16 v[120:123], a[24:27], a[192:195], 0
    ds_read_b128 v[232:235], v16 offset:10240
    ds_read_b128 v[236:239], v17 offset:10240
    v_mfma_f32_16x16x32_bf16 v[120:123], a[28:31], a[196:199], v[120:123]
    s_and_b32 s15, s3, 2
    s_waitcnt vmcnt(16)
    v_mfma_f32_16x16x32_bf16 v[100:103], a[0:3], a[200:203], 0
    ds_read_b128 a[48:51], v25 offset:8192
    ds_read_b128 a[52:55], v25 offset:12288
    v_mfma_f32_16x16x32_bf16 v[100:103], a[4:7], a[204:207], v[100:103]
    s_add_u32 m0, s6, 8192
    s_lshl_b32 s35, s4, 6
    v_mfma_f32_16x16x32_bf16 v[108:111], a[8:11], a[200:203], 0
    ds_read_b128 a[56:59], v25 offset:9216
    ds_read_b128 a[60:63], v25 offset:13312
    v_mfma_f32_16x16x32_bf16 v[108:111], a[12:15], a[204:207], v[108:111]
    s_waitcnt lgkmcnt(6)
    buffer_load_dwordx4 v4, s[64:67], s21 offen offset:0  lds
    v_mfma_f32_16x16x32_bf16 v[116:119], a[16:19], a[200:203], 0
    ds_read_b64_tr_b16 a[192:193], v20 offset:12288
    ds_read_b64_tr_b16 a[194:195], v20 offset:13312
    v_mfma_f32_16x16x32_bf16 v[116:119], a[20:23], a[204:207], v[116:119]
    buffer_load_dwordx4 v5, s[64:67], s21 offen offset:1024  lds
    v_mfma_f32_16x16x32_bf16 v[124:127], a[24:27], a[200:203], 0
    ds_read_b64_tr_b16 a[196:197], v20 offset:14336
    ds_read_b64_tr_b16 a[198:199], v20 offset:15360
    v_mfma_f32_16x16x32_bf16 v[124:127], a[28:31], a[204:207], v[124:127]
    s_lshl1_add_u32 s35, s15, s35
    s_waitcnt lgkmcnt(4)
    v_mfma_f32_16x16x32_bf16 v[96:99], a[32:35], a[208:211], v[96:99]
    ds_read_b128 a[64:67], v24 offset:16384
    ds_read_b128 a[68:71], v24 offset:20480
    v_mfma_f32_16x16x32_bf16 v[96:99], a[36:39], a[212:215], v[96:99]
    buffer_load_dwordx4 v6, s[64:67], s21 offen offset:2048  lds
    v_mfma_f32_16x16x32_bf16 v[104:107], a[40:43], a[208:211], v[104:107]
    ds_read_b128 a[72:75], v24 offset:17408
    ds_read_b128 a[76:79], v24 offset:21504
    v_mfma_f32_16x16x32_bf16 v[104:107], a[44:47], a[212:215], v[104:107]
    buffer_load_dwordx4 v7, s[64:67], s21 offen offset:3072  lds
    v_mfma_f32_16x16x32_bf16 v[112:115], a[48:51], a[208:211], v[112:115]
    ds_read_b64_tr_b16 a[200:201], v21 offset:12288
    ds_read_b64_tr_b16 a[202:203], v21 offset:13312
    v_mfma_f32_16x16x32_bf16 v[112:115], a[52:55], a[212:215], v[112:115]
    s_mul_i32 s35, s35, 1792
    s_and_b32 s14, s3, 1
    v_mfma_f32_16x16x32_bf16 v[120:123], a[56:59], a[208:211], v[120:123]
    ds_read_b64_tr_b16 a[204:205], v21 offset:14336
    ds_read_b64_tr_b16 a[206:207], v21 offset:15360
    v_mfma_f32_16x16x32_bf16 v[120:123], a[60:63], a[212:215], v[120:123]
    s_lshl1_add_u32 s14, s5, s14
    s_waitcnt vmcnt(16)
    v_mfma_f32_16x16x32_bf16 v[100:103], a[32:35], a[216:219], v[100:103]
L_pg4:
    s_cbranch_execz L_pg_ret
    ds_read_b128 a[80:83], v25 offset:16384
    ds_read_b128 a[84:87], v25 offset:20480
    v_mfma_f32_16x16x32_bf16 v[100:103], a[36:39], a[220:223], v[100:103]
    s_add_u32 m0, s6, 12288
    s_add_u32 s7, s18, s0
    v_mfma_f32_16x16x32_bf16 v[108:111], a[40:43], a[216:219], v[108:111]
    ds_read_b128 a[88:91], v25 offset:17408
    ds_read_b128 a[92:95], v25 offset:21504
    v_mfma_f32_16x16x32_bf16 v[108:111], a[44:47], a[220:223], v[108:111]
    s_waitcnt lgkmcnt(4)
    buffer_load_dwordx4 v12, s[72:75], s7 offen offset:0  lds
    v_mfma_f32_16x16x32_bf16 v[116:119], a[48:51], a[216:219], v[116:119]
    ds_read_b64_tr_b16 a[208:209], v20 offset:16384
    ds_read_b64_tr_b16 a[210:211], v20 offset:17408
    v_mfma_f32_16x16x32_bf16 v[116:119], a[52:55], a[220:223], v[116:119]
    buffer_load_dwordx4 v13, s[72:75], s7 offen offset:1024  lds
    v_mfma_f32_16x16x32_bf16 v[124:127], a[56:59], a[216:219], v[124:127]
    ds_read_b64_tr_b16 a[212:213], v20 offset:18432
    ds_read_b64_tr_b16 a[214:215], v20 offset:19456
    v_mfma_f32_16x16x32_bf16 v[124:127], a[60:63], a[220:223], v[124:127]
    s_lshl_b32 s14, s14, 7
    s_waitcnt lgkmcnt(4)
    v_mfma_f32_16x16x32_bf16 v[96:99], a[64:67], a[224:227], v[96:99]
    ds_read_b128 a[96:99], v24 offset:24576
    ds_read_b128 a[100:103], v24 offset:28672
    v_mfma_f32_16x16x32_bf16 v[96:99], a[68:71], a[228:231], v[96:99]
    buffer_load_dwordx4 v14, s[72:75], s7 offen offset:2048  lds
    v_mfma_f32_16x16x32_bf16 v[104:107], a[72:75], a[224:227], v[104:107]
    ds_read_b128 a[104:107], v24 offset:25600
    ds_read_b128 a[108:111], v24 offset:29696
    v_mfma_f32_16x16x32_bf16 v[104:107], a[76:79], a[228:231], v[104:107]
    buffer_load_dwordx4 v15, s[72:75], s7 offen offset:3072  lds
    v_mfma_f32_16x16x32_bf16 v[112:115], a[80:83], a[224:227], v[112:115]
    ds_read_b64_tr_b16 a[216:217], v21 offset:16384
    ds_read_b64_tr_b16 a[218:219], v21 offset:17408
    v_mfma_f32_16x16x32_bf16 v[112:115], a[84:87], a[228:231], v[112:115]
    s_add_u32 s35, s35, s14
    v_lshrrev_b32 v244, 5, v0
    v_mfma_f32_16x16x32_bf16 v[120:123], a[88:91], a[224:227], v[120:123]
    ds_read_b64_tr_b16 a[220:221], v21 offset:18432
    ds_read_b64_tr_b16 a[222:223], v21 offset:19456
    v_mfma_f32_16x16x32_bf16 v[120:123], a[92:95], a[228:231], v[120:123]
    v_mul_u32_u24 v1, 57344, v244
    s_waitcnt vmcnt(16)
    v_mfma_f32_16x16x32_bf16 v[100:103], a[64:67], a[232:235], v[100:103]
    ds_read_b128 a[112:115], v25 offset:24576
    ds_read_b128 a[116:119], v25 offset:28672
    v_mfma_f32_16x16x32_bf16 v[100:103], a[68:71], a[236:239], v[100:103]
    s_add_u32 m0, s6, 16384
    s_add_u32 s7, s18, s1
    v_mfma_f32_16x16x32_bf16 v[108:111], a[72:75], a[232:235], v[108:111]
    ds_read_b128 a[120:123], v25 offset:25600
    ds_read_b128 a[124:127], v25 offset:29696
    v_mfma_f32_16x16x32_bf16 v[108:111], a[76:79], a[236:239], v[108:111]
    s_waitcnt lgkmcnt(4)
    buffer_load_dwordx4 v12, s[72:75], s7 offen offset:0  lds
    v_mfma_f32_16x16x32_bf16 v[116:119], a[80:83], a[232:235], v[116:119]
    ds_read_b64_tr_b16 a[224:225], v20 offset:20480
    ds_read_b64_tr_b16 a[226:227], v20 offset:21504
    v_mfma_f32_16x16x32_bf16 v[116:119], a[84:87], a[236:239], v[116:119]
    buffer_load_dwordx4 v13, s[72:75], s7 offen offset:1024  lds
    v_mfma_f32_16x16x32_bf16 v[124:127], a[88:91], a[232:235], v[124:127]
    ds_read_b64_tr_b16 a[228:229], v20 offset:22528
    ds_read_b64_tr_b16 a[230:231], v20 offset:23552
    v_mfma_f32_16x16x32_bf16 v[124:127], a[92:95], a[236:239], v[124:127]
    v_and_b32 v244, 31, v0
    s_waitcnt lgkmcnt(4)
    v_mfma_f32_16x16x32_bf16 v[96:99], a[96:99], a[240:243], v[96:99]
    ds_read_b64_tr_b16 a[128:129], v32 offset:32768
    ds_read_b64_tr_b16 a[130:131], v33 offset:33280
    v_mfma_f32_16x16x32_bf16 v[96:99], a[100:103], a[244:247], v[96:99]
    buffer_load_dwordx4 v14, s[72:75], s7 offen offset:2048  lds
    v_mfma_f32_16x16x32_bf16 v[104:107], a[104:107], a[240:243], v[104:107]
    ds_read_b64_tr_b16 a[132:133], v32 offset:36864
    ds_read_b64_tr_b16 a[134:135], v33 offset:37376
    v_mfma_f32_16x16x32_bf16 v[104:107], a[108:111], a[244:247], v[104:107]
    buffer_load_dwordx4 v15, s[72:75], s7 offen offset:3072  lds
    v_mfma_f32_16x16x32_bf16 v[112:115], a[112:115], a[240:243], v[112:115]
    ds_read_b64_tr_b16 a[136:137], v34 offset:32768
    ds_read_b64_tr_b16 a[138:139], v35 offset:33280
    v_mfma_f32_16x16x32_bf16 v[112:115], a[116:119], a[244:247], v[112:115]
    ds_read_b64_tr_b16 a[140:141], v34 offset:36864
    ds_read_b64_tr_b16 a[142:143], v35 offset:37376
    v_mfma_f32_16x16x32_bf16 v[120:123], a[120:123], a[240:243], v[120:123]
    ds_read_b64_tr_b16 a[232:233], v21 offset:20480
    ds_read_b64_tr_b16 a[234:235], v21 offset:21504
    v_mfma_f32_16x16x32_bf16 v[120:123], a[124:127], a[244:247], v[120:123]
    ds_read_b64_tr_b16 a[236:237], v21 offset:22528
    ds_read_b64_tr_b16 a[238:239], v21 offset:23552
    s_waitcnt vmcnt(16)
    v_mfma_f32_16x16x32_bf16 v[100:103], a[96:99], a[248:251], v[100:103]
    ds_read_b64_tr_b16 a[144:145], v36 offset:32768
    ds_read_b64_tr_b16 a[146:147], v37 offset:33280
    v_mfma_f32_16x16x32_bf16 v[100:103], a[100:103], a[252:255], v[100:103]
    s_add_u32 m0, s6, 20480
    s_add_u32 s7, s18, s56
    s_waitcnt lgkmcnt(2)
    buffer_load_dwordx4 v12, s[72:75], s7 offen offset:0  lds
    v_mfma_f32_16x16x32_bf16 v[108:111], a[104:107], a[248:251], v[108:111]
    ds_read_b64_tr_b16 a[148:149], v36 offset:36864
    ds_read_b64_tr_b16 a[150:151], v37 offset:37376
    v_mfma_f32_16x16x32_bf16 v[108:111], a[108:111], a[252:255], v[108:111]
    buffer_load_dwordx4 v13, s[72:75], s7 offen offset:1024  lds
    v_mfma_f32_16x16x32_bf16 v[116:119], a[112:115], a[248:251], v[116:119]
    ds_read_b64_tr_b16 a[152:153], v38 offset:32768
    ds_read_b64_tr_b16 a[154:155], v39 offset:33280
    v_mfma_f32_16x16x32_bf16 v[116:119], a[116:119], a[252:255], v[116:119]
    ds_read_b64_tr_b16 a[156:157], v38 offset:36864
    ds_read_b64_tr_b16 a[158:159], v39 offset:37376
    v_mfma_f32_16x16x32_bf16 v[124:127], a[120:123], a[248:251], v[124:127]
    ds_read_b64_tr_b16 a[240:241], v20 offset:0
    ds_read_b64_tr_b16 a[242:243], v20 offset:1024
    v_mfma_f32_16x16x32_bf16 v[124:127], a[124:127], a[252:255], v[124:127]
    ds_read_b64_tr_b16 a[244:245], v20 offset:2048
    ds_read_b64_tr_b16 a[246:247], v20 offset:3072
    s_waitcnt lgkmcnt(4)
    v_mfma_f32_16x16x32_bf16 v[96:99], a[128:131], v[192:195], v[96:99]
    ds_read_b64_tr_b16 a[160:161], v32 offset:40960
    ds_read_b64_tr_b16 a[162:163], v33 offset:41472
    v_mfma_f32_16x16x32_bf16 v[96:99], a[132:135], v[196:199], v[96:99]
    buffer_load_dwordx4 v14, s[72:75], s7 offen offset:2048  lds
    v_mfma_f32_16x16x32_bf16 v[104:107], a[136:139], v[192:195], v[104:107]
    ds_read_b64_tr_b16 a[164:165], v32 offset:45056
    ds_read_b64_tr_b16 a[166:167], v33 offset:45568
    v_mfma_f32_16x16x32_bf16 v[104:107], a[140:143], v[196:199], v[104:107]
    buffer_load_dwordx4 v15, s[72:75], s7 offen offset:3072  lds
    v_mfma_f32_16x16x32_bf16 v[112:115], a[144:147], v[192:195], v[112:115]
    ds_read_b64_tr_b16 a[168:169], v34 offset:40960
    ds_read_b64_tr_b16 a[170:171], v35 offset:41472
    v_mfma_f32_16x16x32_bf16 v[112:115], a[148:151], v[196:199], v[112:115]
    ds_read_b64_tr_b16 a[172:173], v34 offset:45056
    ds_read_b64_tr_b16 a[174:175], v35 offset:45568
    v_mfma_f32_16x16x32_bf16 v[120:123], a[152:155], v[192:195], v[120:123]
    ds_read_b64_tr_b16 a[248:249], v21 offset:0
    ds_read_b64_tr_b16 a[250:251], v21 offset:1024
    v_mfma_f32_16x16x32_bf16 v[120:123], a[156:159], v[196:199], v[120:123]
    ds_read_b64_tr_b16 a[252:253], v21 offset:2048
    ds_read_b64_tr_b16 a[254:255], v21 offset:3072
    s_waitcnt vmcnt(18)
    v_mfma_f32_16x16x32_bf16 v[100:103], a[128:131], v[200:203], v[100:103]
    ds_read_b64_tr_b16 a[176:177], v36 offset:40960
    ds_read_b64_tr_b16 a[178:179], v37 offset:41472
    v_mfma_f32_16x16x32_bf16 v[100:103], a[132:135], v[204:207], v[100:103]
    s_add_u32 m0, s6, 0
    s_add_u32 s7, s18, s57
    v_mfma_f32_16x16x32_bf16 v[108:111], a[136:139], v[200:203], v[108:111]
    ds_read_b64_tr_b16 a[180:181], v36 offset:45056
    ds_read_b64_tr_b16 a[182:183], v37 offset:45568
    v_mfma_f32_16x16x32_bf16 v[108:111], a[140:143], v[204:207], v[108:111]
    s_waitcnt lgkmcnt(4)
    buffer_load_dwordx4 v12, s[72:75], s7 offen offset:0  lds
    v_mfma_f32_16x16x32_bf16 v[116:119], a[144:147], v[200:203], v[116:119]
    ds_read_b64_tr_b16 a[184:185], v38 offset:40960
    ds_read_b64_tr_b16 a[186:187], v39 offset:41472
    v_mfma_f32_16x16x32_bf16 v[116:119], a[148:151], v[204:207], v[116:119]
    buffer_load_dwordx4 v13, s[72:75], s7 offen offset:1024  lds
    v_mfma_f32_16x16x32_bf16 v[124:127], a[152:155], v[200:203], v[124:127]
    ds_read_b64_tr_b16 a[188:189], v38 offset:45056
    ds_read_b64_tr_b16 a[190:191], v39 offset:45568
    v_mfma_f32_16x16x32_bf16 v[124:127], a[156:159], v[204:207], v[124:127]
    ds_read_b128 v[192:195], v16 offset:4096
    ds_read_b128 v[196:199], v17 offset:4096
    s_waitcnt vmcnt(18) lgkmcnt(2)
    v_mfma_f32_16x16x32_bf16 v[96:99], a[160:163], v[224:227], v[96:99]
    ds_read_b128 v[200:203], v16 offset:6144
    ds_read_b128 v[204:207], v17 offset:6144
    v_mfma_f32_16x16x32_bf16 v[96:99], a[164:167], v[228:231], v[96:99]
    buffer_load_dwordx4 v14, s[72:75], s7 offen offset:2048  lds
    v_mfma_f32_16x16x32_bf16 v[104:107], a[168:171], v[224:227], v[104:107]
    buffer_load_dwordx4 v15, s[72:75], s7 offen offset:3072  lds
    v_mfma_f32_16x16x32_bf16 v[104:107], a[172:175], v[228:231], v[104:107]
    v_lshl_add_u32 v1, v244, 2, v1
    v_mfma_f32_16x16x32_bf16 v[112:115], a[176:179], v[224:227], v[112:115]
    v_mfma_f32_16x16x32_bf16 v[112:115], a[180:183], v[228:231], v[112:115]
    v_mfma_f32_16x16x32_bf16 v[120:123], a[184:187], v[224:227], v[120:123]
    v_mfma_f32_16x16x32_bf16 v[120:123], a[188:191], v[228:231], v[120:123]
    s_waitcnt vmcnt(18)
    v_mfma_f32_16x16x32_bf16 v[100:103], a[160:163], v[232:235], v[100:103]
    ds_read_b128 v[224:227], v16 offset:8192
    ds_read_b128 v[228:231], v17 offset:8192
    v_mfma_f32_16x16x32_bf16 v[100:103], a[164:167], v[236:239], v[100:103]
    s_add_u32 m0, s6, 4096
    v_mfma_f32_16x16x32_bf16 v[108:111], a[168:171], v[232:235], v[108:111]
    s_waitcnt lgkmcnt(4)
    buffer_load_dwordx4 v4, s[60:63], s22 offen offset:0  lds
    v_mfma_f32_16x16x32_bf16 v[108:111], a[172:175], v[236:239], v[108:111]
    buffer_load_dwordx4 v5, s[60:63], s22 offen offset:1024  lds
    v_mfma_f32_16x16x32_bf16 v[116:119], a[176:179], v[232:235], v[116:119]
    v_mfma_f32_16x16x32_bf16 v[116:119], a[180:183], v[236:239], v[116:119]
    v_mfma_f32_16x16x32_bf16 v[124:127], a[184:187], v[232:235], v[124:127]
    v_mfma_f32_16x16x32_bf16 v[124:127], a[188:191], v[236:239], v[124:127]
    s_waitcnt vmcnt(18)
    v_mfma_f32_16x16x32_bf16 v[128:131], a[0:3], a[192:195], 0
    ds_read_b128 v[232:235], v16 offset:10240
    ds_read_b128 v[236:239], v17 offset:10240
    v_mfma_f32_16x16x32_bf16 v[128:131], a[4:7], a[196:199], v[128:131]
    s_waitcnt lgkmcnt(4)
    buffer_load_dwordx4 v6, s[60:63], s22 offen offset:2048  lds
    v_mfma_f32_16x16x32_bf16 v[136:139], a[8:11], a[192:195], 0
    buffer_load_dwordx4 v7, s[60:63], s22 offen offset:3072  lds
    v_mfma_f32_16x16x32_bf16 v[136:139], a[12:15], a[196:199], v[136:139]
    s_lshr_b32 s13, s24, 2
    s_and_b32 s95, s24, 1
    v_mfma_f32_16x16x32_bf16 v[144:147], a[16:19], a[192:195], 0
    s_or_b32 s13, s13, s95
    s_lshl_b32 s13, s13, 12
    v_mfma_f32_16x16x32_bf16 v[144:147], a[20:23], a[196:199], v[144:147]
    s_add_u32 s13, s13, 1048576
    v_cvt_pk_bf16_f32 v96, v96, v97
    v_mfma_f32_16x16x32_bf16 v[152:155], a[24:27], a[192:195], 0
    v_cvt_pk_bf16_f32 v97, v98, v99
    v_cvt_pk_bf16_f32 v98, v100, v101
    v_mfma_f32_16x16x32_bf16 v[152:155], a[28:31], a[196:199], v[152:155]
    v_cvt_pk_bf16_f32 v99, v102, v103
    s_waitcnt vmcnt(16)
    v_mfma_f32_16x16x32_bf16 v[132:135], a[0:3], a[200:203], 0
    ds_read_b64_tr_b16 a[192:193], v20 offset:12288
    ds_read_b64_tr_b16 a[194:195], v20 offset:13312
    v_mfma_f32_16x16x32_bf16 v[132:135], a[4:7], a[204:207], v[132:135]
    s_add_u32 m0, s6, 8192
    v_cvt_pk_bf16_f32 v104, v104, v105
    v_mfma_f32_16x16x32_bf16 v[140:143], a[8:11], a[200:203], 0
    ds_read_b64_tr_b16 a[196:197], v20 offset:14336
    ds_read_b64_tr_b16 a[198:199], v20 offset:15360
    v_mfma_f32_16x16x32_bf16 v[140:143], a[12:15], a[204:207], v[140:143]
    s_waitcnt lgkmcnt(6)
    buffer_load_dwordx4 v4, s[64:67], s22 offen offset:0  lds
    v_mfma_f32_16x16x32_bf16 v[148:151], a[16:19], a[200:203], 0
    buffer_load_dwordx4 v5, s[64:67], s22 offen offset:1024  lds
    v_mfma_f32_16x16x32_bf16 v[148:151], a[20:23], a[204:207], v[148:151]
    v_cvt_pk_bf16_f32 v105, v106, v107
    v_cvt_pk_bf16_f32 v106, v108, v109
    v_mfma_f32_16x16x32_bf16 v[156:159], a[24:27], a[200:203], 0
    v_cvt_pk_bf16_f32 v107, v110, v111
    v_cvt_pk_bf16_f32 v112, v112, v113
    v_mfma_f32_16x16x32_bf16 v[156:159], a[28:31], a[204:207], v[156:159]
    v_cvt_pk_bf16_f32 v113, v114, v115
    v_mfma_f32_16x16x32_bf16 v[128:131], a[32:35], a[208:211], v[128:131]
    ds_read_b64_tr_b16 a[200:201], v21 offset:12288
    ds_read_b64_tr_b16 a[202:203], v21 offset:13312
    v_mfma_f32_16x16x32_bf16 v[128:131], a[36:39], a[212:215], v[128:131]
    s_waitcnt lgkmcnt(6)
    buffer_load_dwordx4 v6, s[64:67], s22 offen offset:2048  lds
    v_mfma_f32_16x16x32_bf16 v[136:139], a[40:43], a[208:211], v[136:139]
    ds_read_b64_tr_b16 a[204:205], v21 offset:14336
    ds_read_b64_tr_b16 a[206:207], v21 offset:15360
    v_mfma_f32_16x16x32_bf16 v[136:139], a[44:47], a[212:215], v[136:139]
    buffer_load_dwordx4 v7, s[64:67], s22 offen offset:3072  lds
    v_mfma_f32_16x16x32_bf16 v[144:147], a[48:51], a[208:211], v[144:147]
    buffer_store_dwordx4 v[96:99], v24, s[80:83], s13 offen offset:0 sc1
    v_mfma_f32_16x16x32_bf16 v[144:147], a[52:55], a[212:215], v[144:147]
    v_cvt_pk_bf16_f32 v114, v116, v117
    v_cvt_pk_bf16_f32 v115, v118, v119
    v_mfma_f32_16x16x32_bf16 v[152:155], a[56:59], a[208:211], v[152:155]
    v_cvt_pk_bf16_f32 v120, v120, v121
    v_cvt_pk_bf16_f32 v121, v122, v123
    v_mfma_f32_16x16x32_bf16 v[152:155], a[60:63], a[212:215], v[152:155]
    v_cvt_pk_bf16_f32 v122, v124, v125
    s_waitcnt vmcnt(17)
    v_mfma_f32_16x16x32_bf16 v[132:135], a[32:35], a[216:219], v[132:135]
    ds_read_b64_tr_b16 a[208:209], v20 offset:16384
    ds_read_b64_tr_b16 a[210:211], v20 offset:17408
    v_mfma_f32_16x16x32_bf16 v[132:135], a[36:39], a[220:223], v[132:135]
    buffer_store_dwordx4 v[104:107], v24, s[80:83], s13 offen offset:1024 sc1
    v_mfma_f32_16x16x32_bf16 v[140:143], a[40:43], a[216:219], v[140:143]
    ds_read_b64_tr_b16 a[212:213], v20 offset:18432
    ds_read_b64_tr_b16 a[214:215], v20 offset:19456
    v_mfma_f32_16x16x32_bf16 v[140:143], a[44:47], a[220:223], v[140:143]
    v_cvt_pk_bf16_f32 v123, v126, v127
    v_mfma_f32_16x16x32_bf16 v[148:151], a[48:51], a[216:219], v[148:151]
    ds_read_b128 v[44:47], v211 offset:57344
    ds_read_b128 v[48:51], v211 offset:57360
    v_mfma_f32_16x16x32_bf16 v[148:151], a[52:55], a[220:223], v[148:151]
    ds_read_b128 v[52:55], v211 offset:57600
    ds_read_b128 v[56:59], v211 offset:57616
    v_mfma_f32_16x16x32_bf16 v[156:159], a[56:59], a[216:219], v[156:159]
    v_lshlrev_b32 v212, 16, v212
    v_lshlrev_b32 v213, 16, v213
    v_mfma_f32_16x16x32_bf16 v[156:159], a[60:63], a[220:223], v[156:159]
    v_lshlrev_b32 v160, 16, v160
    v_mfma_f32_16x16x32_bf16 v[128:131], a[64:67], a[224:227], v[128:131]
    ds_read_b64_tr_b16 a[216:217], v21 offset:16384
    ds_read_b64_tr_b16 a[218:219], v21 offset:17408
    v_mfma_f32_16x16x32_bf16 v[128:131], a[68:71], a[228:231], v[128:131]
    buffer_store_dwordx4 v[112:115], v25, s[80:83], s13 offen offset:0 sc1
    v_mfma_f32_16x16x32_bf16 v[136:139], a[72:75], a[224:227], v[136:139]
    ds_read_b64_tr_b16 a[220:221], v21 offset:18432
    ds_read_b64_tr_b16 a[222:223], v21 offset:19456
    v_mfma_f32_16x16x32_bf16 v[136:139], a[76:79], a[228:231], v[136:139]
    v_lshlrev_b32 v161, 16, v161
    v_lshlrev_b32 v162, 16, v162
    v_mfma_f32_16x16x32_bf16 v[144:147], a[80:83], a[224:227], v[144:147]
    v_lshlrev_b32 v163, 16, v163
    v_lshlrev_b32 v164, 16, v164
    v_mfma_f32_16x16x32_bf16 v[144:147], a[84:87], a[228:231], v[144:147]
    v_lshlrev_b32 v165, 16, v165
    v_lshlrev_b32 v166, 16, v166
    v_mfma_f32_16x16x32_bf16 v[152:155], a[88:91], a[224:227], v[152:155]
    v_lshlrev_b32 v167, 16, v167
    v_lshlrev_b32 v168, 16, v168
    v_mfma_f32_16x16x32_bf16 v[152:155], a[92:95], a[228:231], v[152:155]
    v_lshlrev_b32 v169, 16, v169
    s_waitcnt vmcnt(15)
    v_mfma_f32_16x16x32_bf16 v[132:135], a[64:67], a[232:235], v[132:135]
    ds_read_b64_tr_b16 a[224:225], v20 offset:20480
    ds_read_b64_tr_b16 a[226:227], v20 offset:21504
    v_mfma_f32_16x16x32_bf16 v[132:135], a[68:71], a[236:239], v[132:135]
    buffer_store_dwordx4 v[120:123], v25, s[80:83], s13 offen offset:1024 sc1
    v_mfma_f32_16x16x32_bf16 v[140:143], a[72:75], a[232:235], v[140:143]
    ds_read_b64_tr_b16 a[228:229], v20 offset:22528
    ds_read_b64_tr_b16 a[230:231], v20 offset:23552
    v_mfma_f32_16x16x32_bf16 v[140:143], a[76:79], a[236:239], v[140:143]
    v_lshlrev_b32 v170, 16, v170
    v_lshlrev_b32 v171, 16, v171
    v_mfma_f32_16x16x32_bf16 v[148:151], a[80:83], a[232:235], v[148:151]
    v_lshlrev_b32 v172, 16, v172
    v_lshlrev_b32 v173, 16, v173
    v_mfma_f32_16x16x32_bf16 v[148:151], a[84:87], a[236:239], v[148:151]
    v_lshlrev_b32 v174, 16, v174
    v_lshlrev_b32 v175, 16, v175
    v_mfma_f32_16x16x32_bf16 v[156:159], a[88:91], a[232:235], v[156:159]
    s_waitcnt lgkmcnt(6)
    v_add_f32 v248, v44, v160
    v_add_f32 v249, v45, v161
    v_mfma_f32_16x16x32_bf16 v[156:159], a[92:95], a[236:239], v[156:159]
    v_mul_f32 v248, v248, v52
    v_mfma_f32_16x16x32_bf16 v[128:131], a[96:99], a[240:243], v[128:131]
    ds_read_b64_tr_b16 a[232:233], v21 offset:20480
    ds_read_b64_tr_b16 a[234:235], v21 offset:21504
    v_mfma_f32_16x16x32_bf16 v[128:131], a[100:103], a[244:247], v[128:131]
    v_mul_f32 v249, v249, v53
    v_fmac_f32 v160, v248, v212
    v_mfma_f32_16x16x32_bf16 v[136:139], a[104:107], a[240:243], v[136:139]
    ds_read_b64_tr_b16 a[236:237], v21 offset:22528
    ds_read_b64_tr_b16 a[238:239], v21 offset:23552
    v_mfma_f32_16x16x32_bf16 v[136:139], a[108:111], a[244:247], v[136:139]
    v_fmac_f32 v161, v249, v212
    v_add_f32 v250, v46, v162
    v_mfma_f32_16x16x32_bf16 v[144:147], a[112:115], a[240:243], v[144:147]
    v_add_f32 v251, v47, v163
    v_mul_f32 v250, v250, v54
    v_mfma_f32_16x16x32_bf16 v[144:147], a[116:119], a[244:247], v[144:147]
    v_mul_f32 v251, v251, v55
    v_fmac_f32 v162, v250, v212
    v_mfma_f32_16x16x32_bf16 v[152:155], a[120:123], a[240:243], v[152:155]
    v_fmac_f32 v163, v251, v212
    v_add_f32 v248, v44, v164
    v_mfma_f32_16x16x32_bf16 v[152:155], a[124:127], a[244:247], v[152:155]
    v_add_f32 v249, v45, v165
    s_waitcnt vmcnt(12)
    v_mfma_f32_16x16x32_bf16 v[132:135], a[96:99], a[248:251], v[132:135]
    ds_read_b64_tr_b16 a[240:241], v20 offset:0
    ds_read_b64_tr_b16 a[242:243], v20 offset:1024
    v_mfma_f32_16x16x32_bf16 v[132:135], a[100:103], a[252:255], v[132:135]
    s_add_u32 m0, s6, 12288
    s_add_u32 s7, s19, s48
    v_mfma_f32_16x16x32_bf16 v[140:143], a[104:107], a[248:251], v[140:143]
    ds_read_b64_tr_b16 a[244:245], v20 offset:2048
    ds_read_b64_tr_b16 a[246:247], v20 offset:3072
    v_mfma_f32_16x16x32_bf16 v[140:143], a[108:111], a[252:255], v[140:143]
    buffer_load_dwordx4 v12, s[72:75], s7 offen offset:0  lds
    v_mfma_f32_16x16x32_bf16 v[148:151], a[112:115], a[248:251], v[148:151]
    buffer_load_dwordx4 v13, s[72:75], s7 offen offset:1024  lds
    v_mfma_f32_16x16x32_bf16 v[148:151], a[116:119], a[252:255], v[148:151]
    v_mul_f32 v248, v248, v52
    v_mul_f32 v249, v249, v53
    v_mfma_f32_16x16x32_bf16 v[156:159], a[120:123], a[248:251], v[156:159]
    v_fmac_f32 v164, v248, v213
    v_fmac_f32 v165, v249, v213
    v_mfma_f32_16x16x32_bf16 v[156:159], a[124:127], a[252:255], v[156:159]
    v_add_f32 v250, v46, v166
    v_mfma_f32_16x16x32_bf16 v[128:131], a[128:131], v[192:195], v[128:131]
    ds_read_b64_tr_b16 a[248:249], v21 offset:0
    ds_read_b64_tr_b16 a[250:251], v21 offset:1024
    v_mfma_f32_16x16x32_bf16 v[128:131], a[132:135], v[196:199], v[128:131]
    buffer_load_dwordx4 v14, s[72:75], s7 offen offset:2048  lds
    v_mfma_f32_16x16x32_bf16 v[136:139], a[136:139], v[192:195], v[136:139]
    ds_read_b64_tr_b16 a[252:253], v21 offset:2048
    ds_read_b64_tr_b16 a[254:255], v21 offset:3072
    v_mfma_f32_16x16x32_bf16 v[136:139], a[140:143], v[196:199], v[136:139]
    buffer_load_dwordx4 v15, s[72:75], s7 offen offset:3072  lds
    v_mfma_f32_16x16x32_bf16 v[144:147], a[144:147], v[192:195], v[144:147]
    v_add_f32 v251, v47, v167
    v_mul_f32 v250, v250, v54
    v_mfma_f32_16x16x32_bf16 v[144:147], a[148:151], v[196:199], v[144:147]
    v_mul_f32 v251, v251, v55
    v_fmac_f32 v166, v250, v213
    v_mfma_f32_16x16x32_bf16 v[152:155], a[152:155], v[192:195], v[152:155]
    v_fmac_f32 v167, v251, v213
    v_add_f32 v248, v48, v168
    v_mfma_f32_16x16x32_bf16 v[152:155], a[156:159], v[196:199], v[152:155]
    v_add_f32 v249, v49, v169
    s_waitcnt vmcnt(14)
    v_mfma_f32_16x16x32_bf16 v[132:135], a[128:131], v[200:203], v[132:135]
    ds_read_b128 v[192:195], v16 offset:4096
    ds_read_b128 v[196:199], v17 offset:4096
    v_mfma_f32_16x16x32_bf16 v[132:135], a[132:135], v[204:207], v[132:135]
    s_add_u32 m0, s6, 16384
    s_add_u32 s7, s19, s49
    v_mfma_f32_16x16x32_bf16 v[140:143], a[136:139], v[200:203], v[140:143]
    s_waitcnt lgkmcnt(6)
    buffer_load_dwordx4 v12, s[72:75], s7 offen offset:0  lds
    v_mfma_f32_16x16x32_bf16 v[140:143], a[140:143], v[204:207], v[140:143]
    buffer_load_dwordx4 v13, s[72:75], s7 offen offset:1024  lds
    v_mfma_f32_16x16x32_bf16 v[148:151], a[144:147], v[200:203], v[148:151]
    v_mul_f32 v248, v248, v56
    v_mul_f32 v249, v249, v57
    v_mfma_f32_16x16x32_bf16 v[148:151], a[148:151], v[204:207], v[148:151]
    v_fmac_f32 v168, v248, v212
    v_fmac_f32 v169, v249, v212
    v_mfma_f32_16x16x32_bf16 v[156:159], a[152:155], v[200:203], v[156:159]
    v_add_f32 v250, v50, v170
    v_add_f32 v251, v51, v171
    v_mfma_f32_16x16x32_bf16 v[156:159], a[156:159], v[204:207], v[156:159]
    v_mul_f32 v250, v250, v58
    s_waitcnt vmcnt(14)
    v_mfma_f32_16x16x32_bf16 v[128:131], a[160:163], v[224:227], v[128:131]
    ds_read_b128 v[200:203], v16 offset:6144
    ds_read_b128 v[204:207], v17 offset:6144
    v_mfma_f32_16x16x32_bf16 v[128:131], a[164:167], v[228:231], v[128:131]
    buffer_load_dwordx4 v14, s[72:75], s7 offen offset:2048  lds
    v_mfma_f32_16x16x32_bf16 v[136:139], a[168:171], v[224:227], v[136:139]
    buffer_load_dwordx4 v15, s[72:75], s7 offen offset:3072  lds
    v_mfma_f32_16x16x32_bf16 v[136:139], a[172:175], v[228:231], v[136:139]
    v_mul_f32 v251, v251, v59
    v_fmac_f32 v170, v250, v212
    v_mfma_f32_16x16x32_bf16 v[144:147], a[176:179], v[224:227], v[144:147]
    v_fmac_f32 v171, v251, v212
    v_add_f32 v248, v48, v172
    v_mfma_f32_16x16x32_bf16 v[144:147], a[180:183], v[228:231], v[144:147]
    v_add_f32 v249, v49, v173
    v_mul_f32 v248, v248, v56
    v_mfma_f32_16x16x32_bf16 v[152:155], a[184:187], v[224:227], v[152:155]
    v_mul_f32 v249, v249, v57
    v_fmac_f32 v172, v248, v213
    v_mfma_f32_16x16x32_bf16 v[152:155], a[188:191], v[228:231], v[152:155]
    v_fmac_f32 v173, v249, v213
    s_waitcnt vmcnt(14)
    v_mfma_f32_16x16x32_bf16 v[132:135], a[160:163], v[232:235], v[132:135]
    ds_read_b128 v[224:227], v16 offset:8192
    ds_read_b128 v[228:231], v17 offset:8192
    v_mfma_f32_16x16x32_bf16 v[132:135], a[164:167], v[236:239], v[132:135]
    s_add_u32 m0, s6, 20480
    v_add_f32 v250, v50, v174
    v_mfma_f32_16x16x32_bf16 v[140:143], a[168:171], v[232:235], v[140:143]
    buffer_load_dwordx4 v4, s[52:55], s23 offen offset:0  lds
    v_mfma_f32_16x16x32_bf16 v[140:143], a[172:175], v[236:239], v[140:143]
    buffer_load_dwordx4 v5, s[52:55], s23 offen offset:1024  lds
    v_mfma_f32_16x16x32_bf16 v[148:151], a[176:179], v[232:235], v[148:151]
    s_andn2_b32 s24, s24, 7
    s_lshl4_add_u32 s24, s24, 114688
    v_mfma_f32_16x16x32_bf16 v[148:151], a[180:183], v[236:239], v[148:151]
    s_mov_b32 s28, 1
    s_waitcnt vmcnt(10)
    s_atomic_add s28, s[80:81], s24
    v_mfma_f32_16x16x32_bf16 v[156:159], a[184:187], v[232:235], v[156:159]
    v_add_f32 v251, v51, v175
    v_mul_f32 v250, v250, v58
    v_mfma_f32_16x16x32_bf16 v[156:159], a[188:191], v[236:239], v[156:159]
    v_mul_f32 v251, v251, v59
    v_mfma_f32_16x16x32_bf16 v[64:67], a[0:3], a[192:195], 0
    ds_read_b128 v[232:235], v16 offset:10240
    ds_read_b128 v[236:239], v17 offset:10240
    v_mfma_f32_16x16x32_bf16 v[64:67], a[4:7], a[196:199], v[64:67]
    buffer_load_dwordx4 v6, s[52:55], s23 offen offset:2048  lds
    v_mfma_f32_16x16x32_bf16 v[72:75], a[8:11], a[192:195], 0
    buffer_load_dwordx4 v7, s[52:55], s23 offen offset:3072  lds
    v_mfma_f32_16x16x32_bf16 v[72:75], a[12:15], a[196:199], v[72:75]
    s_lshr_b32 s47, s25, 2
    s_and_b32 s95, s25, 1
    v_mfma_f32_16x16x32_bf16 v[80:83], a[16:19], a[192:195], 0
    s_or_b32 s47, s47, s95
    s_lshl_b32 s47, s47, 12
    v_mfma_f32_16x16x32_bf16 v[80:83], a[20:23], a[196:199], v[80:83]
    s_add_u32 s47, s47, 4718592
    v_cvt_pk_bf16_f32 v128, v128, v129
    v_mfma_f32_16x16x32_bf16 v[88:91], a[24:27], a[192:195], 0
    v_cvt_pk_bf16_f32 v129, v130, v131
    v_cvt_pk_bf16_f32 v130, v132, v133
    v_mfma_f32_16x16x32_bf16 v[88:91], a[28:31], a[196:199], v[88:91]
    v_cvt_pk_bf16_f32 v131, v134, v135
    v_mfma_f32_16x16x32_bf16 v[68:71], a[0:3], a[200:203], 0
    v_cvt_pk_bf16_f32 v136, v136, v137
    v_cvt_pk_bf16_f32 v137, v138, v139
    v_mfma_f32_16x16x32_bf16 v[68:71], a[4:7], a[204:207], v[68:71]
    v_cvt_pk_bf16_f32 v138, v140, v141
    v_cvt_pk_bf16_f32 v139, v142, v143
    v_mfma_f32_16x16x32_bf16 v[76:79], a[8:11], a[200:203], 0
    v_cvt_pk_bf16_f32 v144, v144, v145
    v_cvt_pk_bf16_f32 v145, v146, v147
    v_mfma_f32_16x16x32_bf16 v[76:79], a[12:15], a[204:207], v[76:79]
    v_cvt_pk_bf16_f32 v146, v148, v149
    v_cvt_pk_bf16_f32 v147, v150, v151
    v_mfma_f32_16x16x32_bf16 v[84:87], a[16:19], a[200:203], 0
    v_cvt_pk_bf16_f32 v152, v152, v153
    v_cvt_pk_bf16_f32 v153, v154, v155
    v_mfma_f32_16x16x32_bf16 v[84:87], a[20:23], a[204:207], v[84:87]
    v_cvt_pk_bf16_f32 v154, v156, v157
    v_cvt_pk_bf16_f32 v155, v158, v159
    v_mfma_f32_16x16x32_bf16 v[92:95], a[24:27], a[200:203], 0
    v_fmac_f32 v174, v250, v213
    v_fmac_f32 v175, v251, v213
    v_mfma_f32_16x16x32_bf16 v[92:95], a[28:31], a[204:207], v[92:95]
    s_lshr_b32 s13, s26, 2
    v_mfma_f32_16x16x32_bf16 v[64:67], a[32:35], a[208:211], v[64:67]
    s_and_b32 s95, s26, 1
    s_or_b32 s13, s13, s95
    v_mfma_f32_16x16x32_bf16 v[64:67], a[36:39], a[212:215], v[64:67]
    s_lshl_b32 s13, s13, 12
    s_add_u32 s13, s13, 8388608
    v_mfma_f32_16x16x32_bf16 v[72:75], a[40:43], a[208:211], v[72:75]
    s_lshr_b32 s15, s3, 1
    s_mul_i32 s15, s15, 49152
    v_mfma_f32_16x16x32_bf16 v[72:75], a[44:47], a[212:215], v[72:75]
    s_sub_u32 s15, 12288, s15
    v_mfma_f32_16x16x32_bf16 v[80:83], a[48:51], a[208:211], v[80:83]
    v_mfma_f32_16x16x32_bf16 v[80:83], a[52:55], a[212:215], v[80:83]
    v_mfma_f32_16x16x32_bf16 v[88:91], a[56:59], a[208:211], v[88:91]
    v_mfma_f32_16x16x32_bf16 v[88:91], a[60:63], a[212:215], v[88:91]
    v_mfma_f32_16x16x32_bf16 v[68:71], a[32:35], a[216:219], v[68:71]
    buffer_store_dwordx4 v[128:131], v24, s[80:83], s47 offen offset:0 sc1
    v_mfma_f32_16x16x32_bf16 v[68:71], a[36:39], a[220:223], v[68:71]
    v_mfma_f32_16x16x32_bf16 v[76:79], a[40:43], a[216:219], v[76:79]
    v_mfma_f32_16x16x32_bf16 v[76:79], a[44:47], a[220:223], v[76:79]
    v_mfma_f32_16x16x32_bf16 v[84:87], a[48:51], a[216:219], v[84:87]
    v_mfma_f32_16x16x32_bf16 v[84:87], a[52:55], a[220:223], v[84:87]
    v_mfma_f32_16x16x32_bf16 v[92:95], a[56:59], a[216:219], v[92:95]
    v_mfma_f32_16x16x32_bf16 v[92:95], a[60:63], a[220:223], v[92:95]
    v_mfma_f32_16x16x32_bf16 v[64:67], a[64:67], a[224:227], v[64:67]
    buffer_store_dwordx4 v[136:139], v24, s[80:83], s47 offen offset:1024 sc1
    v_mfma_f32_16x16x32_bf16 v[64:67], a[68:71], a[228:231], v[64:67]
    v_mfma_f32_16x16x32_bf16 v[72:75], a[72:75], a[224:227], v[72:75]
    v_mfma_f32_16x16x32_bf16 v[72:75], a[76:79], a[228:231], v[72:75]
    v_mfma_f32_16x16x32_bf16 v[80:83], a[80:83], a[224:227], v[80:83]
    v_mfma_f32_16x16x32_bf16 v[80:83], a[84:87], a[228:231], v[80:83]
    v_mfma_f32_16x16x32_bf16 v[88:91], a[88:91], a[224:227], v[88:91]
    v_mfma_f32_16x16x32_bf16 v[88:91], a[92:95], a[228:231], v[88:91]
    v_mfma_f32_16x16x32_bf16 v[68:71], a[64:67], a[232:235], v[68:71]
    buffer_store_dwordx4 v[144:147], v25, s[80:83], s47 offen offset:0 sc1
    v_mfma_f32_16x16x32_bf16 v[68:71], a[68:71], a[236:239], v[68:71]
    v_mfma_f32_16x16x32_bf16 v[76:79], a[72:75], a[232:235], v[76:79]
    v_mfma_f32_16x16x32_bf16 v[76:79], a[76:79], a[236:239], v[76:79]
    v_mfma_f32_16x16x32_bf16 v[84:87], a[80:83], a[232:235], v[84:87]
    v_mfma_f32_16x16x32_bf16 v[84:87], a[84:87], a[236:239], v[84:87]
    v_mfma_f32_16x16x32_bf16 v[92:95], a[88:91], a[232:235], v[92:95]
    v_mfma_f32_16x16x32_bf16 v[92:95], a[92:95], a[236:239], v[92:95]
    v_mfma_f32_16x16x32_bf16 v[64:67], a[96:99], a[240:243], v[64:67]
    buffer_store_dwordx4 v[152:155], v25, s[80:83], s47 offen offset:1024 sc1
    v_mfma_f32_16x16x32_bf16 v[64:67], a[100:103], a[244:247], v[64:67]
    v_mfma_f32_16x16x32_bf16 v[72:75], a[104:107], a[240:243], v[72:75]
    v_mfma_f32_16x16x32_bf16 v[72:75], a[108:111], a[244:247], v[72:75]
    v_mfma_f32_16x16x32_bf16 v[80:83], a[112:115], a[240:243], v[80:83]
    v_mfma_f32_16x16x32_bf16 v[80:83], a[116:119], a[244:247], v[80:83]
    v_mfma_f32_16x16x32_bf16 v[88:91], a[120:123], a[240:243], v[88:91]
    v_mfma_f32_16x16x32_bf16 v[88:91], a[124:127], a[244:247], v[88:91]
    s_waitcnt lgkmcnt(6)
    v_mfma_f32_16x16x32_bf16 v[68:71], a[96:99], a[248:251], v[68:71]
    v_mfma_f32_16x16x32_bf16 v[68:71], a[100:103], a[252:255], v[68:71]
    v_mfma_f32_16x16x32_bf16 v[76:79], a[104:107], a[248:251], v[76:79]
    v_mfma_f32_16x16x32_bf16 v[76:79], a[108:111], a[252:255], v[76:79]
    v_mfma_f32_16x16x32_bf16 v[84:87], a[112:115], a[248:251], v[84:87]
    v_mfma_f32_16x16x32_bf16 v[84:87], a[116:119], a[252:255], v[84:87]
    v_mfma_f32_16x16x32_bf16 v[92:95], a[120:123], a[248:251], v[92:95]
    v_mfma_f32_16x16x32_bf16 v[92:95], a[124:127], a[252:255], v[92:95]
    v_mfma_f32_16x16x32_bf16 v[64:67], a[128:131], v[192:195], v[64:67]
    s_load_dword s46, s[80:81], s27 glc
    v_mfma_f32_16x16x32_bf16 v[64:67], a[132:135], v[196:199], v[64:67]
    v_mfma_f32_16x16x32_bf16 v[72:75], a[136:139], v[192:195], v[72:75]
    v_mfma_f32_16x16x32_bf16 v[72:75], a[140:143], v[196:199], v[72:75]
    v_mfma_f32_16x16x32_bf16 v[80:83], a[144:147], v[192:195], v[80:83]
    v_mfma_f32_16x16x32_bf16 v[80:83], a[148:151], v[196:199], v[80:83]
    v_mfma_f32_16x16x32_bf16 v[88:91], a[152:155], v[192:195], v[88:91]
L_pg5:
    s_cbranch_execz L_pg_ret
    v_mfma_f32_16x16x32_bf16 v[88:91], a[156:159], v[196:199], v[88:91]
    s_waitcnt lgkmcnt(4)
    v_mfma_f32_16x16x32_bf16 v[68:71], a[128:131], v[200:203], v[68:71]
    v_mfma_f32_16x16x32_bf16 v[68:71], a[132:135], v[204:207], v[68:71]
    v_mfma_f32_16x16x32_bf16 v[76:79], a[136:139], v[200:203], v[76:79]
    v_mfma_f32_16x16x32_bf16 v[76:79], a[140:143], v[204:207], v[76:79]
    v_mfma_f32_16x16x32_bf16 v[84:87], a[144:147], v[200:203], v[84:87]
    v_mfma_f32_16x16x32_bf16 v[84:87], a[148:151], v[204:207], v[84:87]
    v_mfma_f32_16x16x32_bf16 v[92:95], a[152:155], v[200:203], v[92:95]
    v_mfma_f32_16x16x32_bf16 v[92:95], a[156:159], v[204:207], v[92:95]
    s_waitcnt lgkmcnt(2)
    v_mfma_f32_16x16x32_bf16 v[64:67], a[160:163], v[224:227], v[64:67]
    v_mfma_f32_16x16x32_bf16 v[64:67], a[164:167], v[228:231], v[64:67]
    v_mfma_f32_16x16x32_bf16 v[72:75], a[168:171], v[224:227], v[72:75]
    v_mfma_f32_16x16x32_bf16 v[72:75], a[172:175], v[228:231], v[72:75]
    v_mfma_f32_16x16x32_bf16 v[80:83], a[176:179], v[224:227], v[80:83]
    v_mfma_f32_16x16x32_bf16 v[80:83], a[180:183], v[228:231], v[80:83]
    v_mfma_f32_16x16x32_bf16 v[88:91], a[184:187], v[224:227], v[88:91]
    v_mfma_f32_16x16x32_bf16 v[88:91], a[188:191], v[228:231], v[88:91]
    s_waitcnt lgkmcnt(0)
    v_mfma_f32_16x16x32_bf16 v[68:71], a[160:163], v[232:235], v[68:71]
    v_mfma_f32_16x16x32_bf16 v[68:71], a[164:167], v[236:239], v[68:71]
    v_mfma_f32_16x16x32_bf16 v[76:79], a[168:171], v[232:235], v[76:79]
    v_mfma_f32_16x16x32_bf16 v[76:79], a[172:175], v[236:239], v[76:79]
    v_mfma_f32_16x16x32_bf16 v[84:87], a[176:179], v[232:235], v[84:87]
    v_mfma_f32_16x16x32_bf16 v[84:87], a[180:183], v[236:239], v[84:87]
    v_mfma_f32_16x16x32_bf16 v[92:95], a[184:187], v[232:235], v[92:95]
    v_mfma_f32_16x16x32_bf16 v[92:95], a[188:191], v[236:239], v[92:95]
    v_add_u32 v20, s15, v20
    v_add_u32 v21, s15, v21
    v_add_u32 v16, s15, v16
    v_add_u32_e64 v17, s15, v17
    v_cvt_pk_bf16_f32 v64, v64, v65
    v_cvt_pk_bf16_f32 v65, v66, v67
    v_cvt_pk_bf16_f32 v66, v68, v69
    v_cvt_pk_bf16_f32 v67, v70, v71
    buffer_store_dwordx4 v[64:67], v24, s[80:83], s13 offen offset:0 sc1
    v_cvt_pk_bf16_f32 v72, v72, v73
    v_cvt_pk_bf16_f32 v73, v74, v75
    v_cvt_pk_bf16_f32 v74, v76, v77
    v_cvt_pk_bf16_f32 v75, v78, v79
    buffer_store_dwordx4 v[72:75], v24, s[80:83], s13 offen offset:1024 sc1
    v_cvt_pk_bf16_f32 v80, v80, v81
    v_cvt_pk_bf16_f32 v81, v82, v83
    v_cvt_pk_bf16_f32 v82, v84, v85
    v_cvt_pk_bf16_f32 v83, v86, v87
    buffer_store_dwordx4 v[80:83], v25, s[80:83], s13 offen offset:0 sc1
    v_cvt_pk_bf16_f32 v88, v88, v89
    v_cvt_pk_bf16_f32 v89, v90, v91
    v_cvt_pk_bf16_f32 v90, v92, v93
    v_cvt_pk_bf16_f32 v91, v94, v95
    buffer_store_dwordx4 v[88:91], v25, s[80:83], s13 offen offset:1024 sc1
    s_bfe_u32 s95, s46, 524288
    s_cmp_lg_u32 s95, 2
    s_cbranch_scc1 L_p0_spin
L_p0_ok:
    s_add_u32 s14, s12, 0
    buffer_load_dwordx4 v[176:179], v24, s[80:83], s14 offen offset:0 sc1
    buffer_load_dwordx4 v[180:183], v24, s[80:83], s14 offen offset:1024 sc1
    s_add_u32 s14, s12, 4096
    buffer_load_dwordx4 v[184:187], v24, s[80:83], s14 offen offset:0 sc1
    buffer_load_dwordx4 v[188:191], v24, s[80:83], s14 offen offset:1024 sc1
    s_andn2_b32 s25, s25, 7
    s_lshl4_add_u32 s25, s25, 114688
    s_mov_b32 s29, 256
    s_waitcnt vmcnt(8)
    s_atomic_add s29, s[80:81], s25
    s_barrier
    ds_read_b64_tr_b16 a[192:193], v20 offset:0
    ds_read_b64_tr_b16 a[194:195], v20 offset:1024
    ds_read_b64_tr_b16 a[196:197], v20 offset:2048
    ds_read_b64_tr_b16 a[198:199], v20 offset:3072
    ds_read_b64_tr_b16 a[200:201], v21 offset:0
    ds_read_b64_tr_b16 a[202:203], v21 offset:1024
    ds_read_b64_tr_b16 a[204:205], v21 offset:2048
    ds_read_b64_tr_b16 a[206:207], v21 offset:3072
    s_waitcnt lgkmcnt(4)
    v_mfma_f32_16x16x32_bf16 v[96:99], a[0:3], a[192:195], 0
    ds_read_b64_tr_b16 a[208:209], v20 offset:4096
    ds_read_b64_tr_b16 a[210:211], v20 offset:5120
    v_mfma_f32_16x16x32_bf16 v[96:99], a[4:7], a[196:199], v[96:99]
    v_mfma_f32_16x16x32_bf16 v[104:107], a[8:11], a[192:195], 0
    ds_read_b64_tr_b16 a[212:213], v20 offset:6144
    ds_read_b64_tr_b16 a[214:215], v20 offset:7168
    v_mfma_f32_16x16x32_bf16 v[104:107], a[12:15], a[196:199], v[104:107]
    s_waitcnt lgkmcnt(4)
    v_mfma_f32_16x16x32_bf16 v[100:103], a[0:3], a[200:203], 0
    ds_read_b64_tr_b16 a[216:217], v21 offset:4096
    ds_read_b64_tr_b16 a[218:219], v21 offset:5120
    v_mfma_f32_16x16x32_bf16 v[100:103], a[4:7], a[204:207], v[100:103]
    v_mfma_f32_16x16x32_bf16 v[108:111], a[8:11], a[200:203], 0
    ds_read_b64_tr_b16 a[220:221], v21 offset:6144
    ds_read_b64_tr_b16 a[222:223], v21 offset:7168
    v_mfma_f32_16x16x32_bf16 v[108:111], a[12:15], a[204:207], v[108:111]
    s_waitcnt lgkmcnt(4)
    v_mfma_f32_16x16x32_bf16 v[96:99], a[32:35], a[208:211], v[96:99]
    ds_read_b64_tr_b16 a[224:225], v20 offset:49152
    ds_read_b64_tr_b16 a[226:227], v20 offset:50176
    v_mfma_f32_16x16x32_bf16 v[96:99], a[36:39], a[212:215], v[96:99]
    v_mfma_f32_16x16x32_bf16 v[104:107], a[40:43], a[208:211], v[104:107]
    ds_read_b64_tr_b16 a[228:229], v20 offset:51200
    ds_read_b64_tr_b16 a[230:231], v20 offset:52224
    v_mfma_f32_16x16x32_bf16 v[104:107], a[44:47], a[212:215], v[104:107]
    s_waitcnt lgkmcnt(4)
    v_mfma_f32_16x16x32_bf16 v[100:103], a[32:35], a[216:219], v[100:103]
    ds_read_b64_tr_b16 a[232:233], v21 offset:49152
    ds_read_b64_tr_b16 a[234:235], v21 offset:50176
    v_mfma_f32_16x16x32_bf16 v[100:103], a[36:39], a[220:223], v[100:103]
    v_mfma_f32_16x16x32_bf16 v[108:111], a[40:43], a[216:219], v[108:111]
    ds_read_b64_tr_b16 a[236:237], v21 offset:51200
    ds_read_b64_tr_b16 a[238:239], v21 offset:52224
    v_mfma_f32_16x16x32_bf16 v[108:111], a[44:47], a[220:223], v[108:111]
    s_waitcnt lgkmcnt(4)
    v_mfma_f32_16x16x32_bf16 v[96:99], a[64:67], a[224:227], v[96:99]
    ds_read_b64_tr_b16 a[240:241], v20 offset:53248
    ds_read_b64_tr_b16 a[242:243], v20 offset:54272
    v_mfma_f32_16x16x32_bf16 v[96:99], a[68:71], a[228:231], v[96:99]
    v_mfma_f32_16x16x32_bf16 v[104:107], a[72:75], a[224:227], v[104:107]
    ds_read_b64_tr_b16 a[244:245], v20 offset:55296
    ds_read_b64_tr_b16 a[246:247], v20 offset:56320
    v_mfma_f32_16x16x32_bf16 v[104:107], a[76:79], a[228:231], v[104:107]
    s_waitcnt lgkmcnt(4)
    v_mfma_f32_16x16x32_bf16 v[100:103], a[64:67], a[232:235], v[100:103]
    ds_read_b64_tr_b16 a[248:249], v21 offset:53248
    ds_read_b64_tr_b16 a[250:251], v21 offset:54272
    v_mfma_f32_16x16x32_bf16 v[100:103], a[68:71], a[236:239], v[100:103]
    v_mfma_f32_16x16x32_bf16 v[108:111], a[72:75], a[232:235], v[108:111]
    ds_read_b64_tr_b16 a[252:253], v21 offset:55296
    ds_read_b64_tr_b16 a[254:255], v21 offset:56320
    v_mfma_f32_16x16x32_bf16 v[108:111], a[76:79], a[236:239], v[108:111]
    s_waitcnt lgkmcnt(4)
    v_mfma_f32_16x16x32_bf16 v[96:99], a[96:99], a[240:243], v[96:99]
    ds_read_b128 a[192:195], v16 offset:8192
    ds_read_b128 a[196:199], v17 offset:8192
    v_mfma_f32_16x16x32_bf16 v[96:99], a[100:103], a[244:247], v[96:99]
    s_andn2_b32 s26, s26, 7
    s_lshl4_add_u32 s26, s26, 114688
    v_mfma_f32_16x16x32_bf16 v[104:107], a[104:107], a[240:243], v[104:107]
    s_mov_b32 s11, 65536
    s_waitcnt vmcnt(4)
    s_atomic_add s11, s[80:81], s26
    v_mfma_f32_16x16x32_bf16 v[104:107], a[108:111], a[244:247], v[104:107]
    s_waitcnt lgkmcnt(2)
    v_mfma_f32_16x16x32_bf16 v[100:103], a[96:99], a[248:251], v[100:103]
    ds_read_b128 a[200:203], v16 offset:10240
    ds_read_b128 a[204:207], v17 offset:10240
    v_mfma_f32_16x16x32_bf16 v[100:103], a[100:103], a[252:255], v[100:103]
    v_mfma_f32_16x16x32_bf16 v[108:111], a[104:107], a[248:251], v[108:111]
    v_mfma_f32_16x16x32_bf16 v[108:111], a[108:111], a[252:255], v[108:111]
    s_waitcnt lgkmcnt(2)
    v_mfma_f32_16x16x32_bf16 v[96:99], a[128:131], a[192:195], v[96:99]
    ds_read_b128 a[208:211], v16 offset:57344
    ds_read_b128 a[212:215], v17 offset:57344
    v_mfma_f32_16x16x32_bf16 v[96:99], a[132:135], a[196:199], v[96:99]
    s_load_dword s46, s[80:81], s27 glc
    v_mfma_f32_16x16x32_bf16 v[104:107], a[136:139], a[192:195], v[104:107]
    v_mfma_f32_16x16x32_bf16 v[104:107], a[140:143], a[196:199], v[104:107]
    s_waitcnt lgkmcnt(2)
    v_mfma_f32_16x16x32_bf16 v[100:103], a[128:131], a[200:203], v[100:103]
    ds_read_b128 a[216:219], v16 offset:59392
    ds_read_b128 a[220:223], v17 offset:59392
    v_mfma_f32_16x16x32_bf16 v[100:103], a[132:135], a[204:207], v[100:103]
    v_mfma_f32_16x16x32_bf16 v[108:111], a[136:139], a[200:203], v[108:111]
    ds_read_b32 v240, v24
    ds_read_b32 v241, v24
    v_mfma_f32_16x16x32_bf16 v[108:111], a[140:143], a[204:207], v[108:111]
    s_waitcnt lgkmcnt(4)
    v_mfma_f32_16x16x32_bf16 v[96:99], a[160:163], a[208:211], v[96:99]
    v_mfma_f32_16x16x32_bf16 v[96:99], a[164:167], a[212:215], v[96:99]
    v_mfma_f32_16x16x32_bf16 v[104:107], a[168:171], a[208:211], v[104:107]
    v_mfma_f32_16x16x32_bf16 v[104:107], a[172:175], a[212:215], v[104:107]
    s_waitcnt lgkmcnt(2)
    v_mfma_f32_16x16x32_bf16 v[100:103], a[160:163], a[216:219], v[100:103]
    v_mfma_f32_16x16x32_bf16 v[100:103], a[164:167], a[220:223], v[100:103]
    v_mfma_f32_16x16x32_bf16 v[108:111], a[168:171], a[216:219], v[108:111]
    v_mfma_f32_16x16x32_bf16 v[108:111], a[172:175], a[220:223], v[108:111]
    s_waitcnt lgkmcnt(0)
    s_bfe_u32 s95, s46, 524296
    s_cmp_lg_u32 s95, 2
    s_cbranch_scc1 L_p1_spin
L_p1_ok:
    s_add_u32 s14, s12, 3670016
    buffer_load_dwordx4 v[192:195], v24, s[80:83], s14 offen offset:0 sc1
    buffer_load_dwordx4 v[196:199], v24, s[80:83], s14 offen offset:1024 sc1
    s_add_u32 s14, s12, 3674112
    buffer_load_dwordx4 v[200:203], v24, s[80:83], s14 offen offset:0 sc1
    buffer_load_dwordx4 v[204:207], v24, s[80:83], s14 offen offset:1024 sc1
    s_bfe_u32 s95, s46, 524304
    s_cmp_lg_u32 s95, 2
    s_cbranch_scc1 L_p2_spin
L_p2_ok:
    s_add_u32 s14, s12, 7340032
    buffer_load_dwordx4 v[208:211], v24, s[80:83], s14 offen offset:0 sc1
    buffer_load_dwordx4 v[212:215], v24, s[80:83], s14 offen offset:1024 sc1
    s_add_u32 s14, s12, 7344128
    buffer_load_dwordx4 v[216:219], v24, s[80:83], s14 offen offset:0 sc1
    buffer_load_dwordx4 v[220:223], v24, s[80:83], s14 offen offset:1024 sc1
    s_waitcnt vmcnt(11)
    v_dot2_f32_bf16 v96, v176, s8, v96
    v_dot2_f32_bf16 v97, v176, s9, v97
    v_dot2_f32_bf16 v98, v177, s8, v98
    v_dot2_f32_bf16 v99, v177, s9, v99
    v_dot2_f32_bf16 v100, v178, s8, v100
    v_dot2_f32_bf16 v101, v178, s9, v101
    v_dot2_f32_bf16 v102, v179, s8, v102
    v_dot2_f32_bf16 v103, v179, s9, v103
    s_waitcnt vmcnt(10)
    v_dot2_f32_bf16 v104, v180, s8, v104
    v_dot2_f32_bf16 v105, v180, s9, v105
    v_dot2_f32_bf16 v106, v181, s8, v106
    v_dot2_f32_bf16 v107, v181, s9, v107
    v_dot2_f32_bf16 v108, v182, s8, v108
    v_dot2_f32_bf16 v109, v182, s9, v109
    v_dot2_f32_bf16 v110, v183, s8, v110
    v_dot2_f32_bf16 v111, v183, s9, v111
    s_waitcnt vmcnt(9)
    v_dot2_f32_bf16 v96, v184, s8, v96
    v_dot2_f32_bf16 v97, v184, s9, v97
    v_dot2_f32_bf16 v98, v185, s8, v98
    v_dot2_f32_bf16 v99, v185, s9, v99
    v_dot2_f32_bf16 v100, v186, s8, v100
    v_dot2_f32_bf16 v101, v186, s9, v101
    v_dot2_f32_bf16 v102, v187, s8, v102
    v_dot2_f32_bf16 v103, v187, s9, v103
    s_waitcnt vmcnt(8)
    v_dot2_f32_bf16 v104, v188, s8, v104
    v_dot2_f32_bf16 v105, v188, s9, v105
    v_dot2_f32_bf16 v106, v189, s8, v106
    v_dot2_f32_bf16 v107, v189, s9, v107
    v_dot2_f32_bf16 v108, v190, s8, v108
    v_dot2_f32_bf16 v109, v190, s9, v109
    v_dot2_f32_bf16 v110, v191, s8, v110
    v_dot2_f32_bf16 v111, v191, s9, v111
    s_waitcnt vmcnt(7)
    v_dot2_f32_bf16 v96, v192, s8, v96
    v_dot2_f32_bf16 v97, v192, s9, v97
    v_dot2_f32_bf16 v98, v193, s8, v98
    v_dot2_f32_bf16 v99, v193, s9, v99
    v_dot2_f32_bf16 v100, v194, s8, v100
    v_dot2_f32_bf16 v101, v194, s9, v101
    v_dot2_f32_bf16 v102, v195, s8, v102
    v_dot2_f32_bf16 v103, v195, s9, v103
    s_waitcnt vmcnt(6)
    v_dot2_f32_bf16 v104, v196, s8, v104
    v_dot2_f32_bf16 v105, v196, s9, v105
    v_dot2_f32_bf16 v106, v197, s8, v106
    v_dot2_f32_bf16 v107, v197, s9, v107
    v_dot2_f32_bf16 v108, v198, s8, v108
    v_dot2_f32_bf16 v109, v198, s9, v109
    v_dot2_f32_bf16 v110, v199, s8, v110
    v_dot2_f32_bf16 v111, v199, s9, v111
    s_waitcnt vmcnt(5)
    v_dot2_f32_bf16 v96, v200, s8, v96
    v_dot2_f32_bf16 v97, v200, s9, v97
    v_dot2_f32_bf16 v98, v201, s8, v98
    v_dot2_f32_bf16 v99, v201, s9, v99
    v_dot2_f32_bf16 v100, v202, s8, v100
    v_dot2_f32_bf16 v101, v202, s9, v101
    v_dot2_f32_bf16 v102, v203, s8, v102
    v_dot2_f32_bf16 v103, v203, s9, v103
    s_waitcnt vmcnt(4)
    v_dot2_f32_bf16 v104, v204, s8, v104
    v_dot2_f32_bf16 v105, v204, s9, v105
    v_dot2_f32_bf16 v106, v205, s8, v106
    v_dot2_f32_bf16 v107, v205, s9, v107
    v_dot2_f32_bf16 v108, v206, s8, v108
    v_dot2_f32_bf16 v109, v206, s9, v109
    v_dot2_f32_bf16 v110, v207, s8, v110
    v_dot2_f32_bf16 v111, v207, s9, v111
    s_waitcnt vmcnt(3)
    v_dot2_f32_bf16 v96, v208, s8, v96
    v_dot2_f32_bf16 v97, v208, s9, v97
    v_dot2_f32_bf16 v98, v209, s8, v98
    v_dot2_f32_bf16 v99, v209, s9, v99
    v_dot2_f32_bf16 v100, v210, s8, v100
    v_dot2_f32_bf16 v101, v210, s9, v101
    v_dot2_f32_bf16 v102, v211, s8, v102
    v_dot2_f32_bf16 v103, v211, s9, v103
    s_waitcnt vmcnt(2)
    v_dot2_f32_bf16 v104, v212, s8, v104
    v_dot2_f32_bf16 v105, v212, s9, v105
    v_dot2_f32_bf16 v106, v213, s8, v106
    v_dot2_f32_bf16 v107, v213, s9, v107
    v_dot2_f32_bf16 v108, v214, s8, v108
    v_dot2_f32_bf16 v109, v214, s9, v109
    v_dot2_f32_bf16 v110, v215, s8, v110
    v_dot2_f32_bf16 v111, v215, s9, v111
    s_waitcnt vmcnt(1)
    v_dot2_f32_bf16 v96, v216, s8, v96
    v_dot2_f32_bf16 v97, v216, s9, v97
    v_dot2_f32_bf16 v98, v217, s8, v98
    v_dot2_f32_bf16 v99, v217, s9, v99
    v_dot2_f32_bf16 v100, v218, s8, v100
    v_dot2_f32_bf16 v101, v218, s9, v101
    v_dot2_f32_bf16 v102, v219, s8, v102
    v_dot2_f32_bf16 v103, v219, s9, v103
    s_waitcnt vmcnt(0)
    s_nop 0
    v_dot2_f32_bf16 v104, v220, s8, v104
    v_dot2_f32_bf16 v105, v220, s9, v105
    v_dot2_f32_bf16 v106, v221, s8, v106
    v_dot2_f32_bf16 v107, v221, s9, v107
    v_dot2_f32_bf16 v108, v222, s8, v108
    v_dot2_f32_bf16 v109, v222, s9, v109
    v_dot2_f32_bf16 v110, v223, s8, v110
    v_dot2_f32_bf16 v111, v223, s9, v111
    v_pk_fma_f32 v[160:161], v[96:97], s[30:31], v[160:161] op_sel_hi:[1,0,1]
    v_pk_fma_f32 v[162:163], v[98:99], s[30:31], v[162:163] op_sel_hi:[1,0,1]
    v_pk_fma_f32 v[164:165], v[100:101], s[30:31], v[164:165] op_sel_hi:[1,0,1]
    v_pk_fma_f32 v[166:167], v[102:103], s[30:31], v[166:167] op_sel_hi:[1,0,1]
    v_pk_fma_f32 v[168:169], v[104:105], s[30:31], v[168:169] op_sel_hi:[1,0,1]
    v_pk_fma_f32 v[170:171], v[106:107], s[30:31], v[170:171] op_sel_hi:[1,0,1]
    v_pk_fma_f32 v[172:173], v[108:109], s[30:31], v[172:173] op_sel_hi:[1,0,1]
    v_pk_fma_f32 v[174:175], v[110:111], s[30:31], v[174:175] op_sel_hi:[1,0,1]
    v_permlane16_swap_b32 v160, v164
    v_permlane16_swap_b32 v161, v165
    v_permlane16_swap_b32 v162, v166
    v_permlane16_swap_b32 v163, v167
    v_permlane16_swap_b32 v168, v172
    v_permlane16_swap_b32 v169, v173
    v_permlane16_swap_b32 v170, v174
    v_permlane16_swap_b32 v171, v175
    s_add_u32 s14, s35, 0
    s_nop 0
    buffer_store_dword v160, v1, s[76:79], s14 offen offset:0 sc1
    buffer_store_dword v162, v1, s[76:79], s14 offen offset:1792 sc1
    s_add_u32 s14, s35, 14336
    buffer_store_dword v161, v1, s[76:79], s14 offen offset:0 sc1
    buffer_store_dword v163, v1, s[76:79], s14 offen offset:1792 sc1
    s_add_u32 s14, s35, 28672
    buffer_store_dword v164, v1, s[76:79], s14 offen offset:0 sc1
    buffer_store_dword v166, v1, s[76:79], s14 offen offset:1792 sc1
    s_add_u32 s14, s35, 43008
    buffer_store_dword v165, v1, s[76:79], s14 offen offset:0 sc1
    buffer_store_dword v167, v1, s[76:79], s14 offen offset:1792 sc1
    s_add_u32 s14, s35, 3584
    buffer_store_dword v168, v1, s[76:79], s14 offen offset:0 sc1
    buffer_store_dword v170, v1, s[76:79], s14 offen offset:1792 sc1
    s_add_u32 s14, s35, 17920
    buffer_store_dword v169, v1, s[76:79], s14 offen offset:0 sc1
    buffer_store_dword v171, v1, s[76:79], s14 offen offset:1792 sc1
    s_add_u32 s14, s35, 32256
    buffer_store_dword v172, v1, s[76:79], s14 offen offset:0 sc1
    buffer_store_dword v174, v1, s[76:79], s14 offen offset:1792 sc1
    s_add_u32 s14, s35, 46592
    buffer_store_dword v173, v1, s[76:79], s14 offen offset:0 sc1
    buffer_store_dword v175, v1, s[76:79], s14 offen offset:1792 sc1
L_exit:
    s_endpgm
L_clr_spin:
s_cmp_eq_u32 s34, 0
s_cbranch_scc1 L_clr_ok
s_sub_u32 s34, s34, 1
v_mov_b32 v255, 0
global_load_dword v255, v255, s[44:45] sc1
s_waitcnt vmcnt(0)
v_readfirstlane_b32 s46, v255
s_waitcnt vmcnt(0)
s_cmp_lt_u32 s46, 32
s_nop 1
s_cbranch_scc1 L_clr_spin
s_branch L_clr_ok
L_carry_spin:
s_cmp_eq_u32 s34, 0
s_cbranch_scc1 L_carry_ok
s_sub_u32 s34, s34, 1
buffer_load_dwordx2 v[224:225], v42, s[84:87], 0 offen offset:0 sc1
buffer_load_dwordx2 v[226:227], v42, s[84:87], 0 offen offset:128 sc1
buffer_load_dwordx2 v[228:229], v42, s[84:87], 0 offen offset:256 sc1
buffer_load_dwordx2 v[230:231], v42, s[84:87], 0 offen offset:384 sc1
buffer_load_dwordx2 v[232:233], v42, s[84:87], 0 offen offset:512 sc1
buffer_load_dwordx2 v[234:235], v42, s[84:87], 0 offen offset:640 sc1
buffer_load_dwordx2 v[236:237], v42, s[84:87], 0 offen offset:768 sc1
buffer_load_dwordx2 v[238:239], v42, s[84:87], 0 offen offset:896 sc1
s_waitcnt vmcnt(0)
v_max3_u32 v248, v224, v225, v226
v_max3_u32 v248, v248, v227, v228
v_max3_u32 v248, v248, v229, v230
v_max3_u32 v248, v248, v231, v232
v_max3_u32 v248, v248, v233, v234
v_max3_u32 v248, v248, v235, v236
v_max3_u32 v248, v248, v237, v238
v_max_u32 v248, v248, v239
v_cmp_eq_u32 vcc, -1, v248
s_nop 1
s_cbranch_vccnz L_carry_spin
s_branch L_carry_ok
L_p0_spin:
s_cmp_eq_u32 s34, 0
s_cbranch_scc1 L_p0_ok
s_sub_u32 s34, s34, 1
s_load_dword s46, s[80:81], s27 glc
s_waitcnt lgkmcnt(0)
s_bfe_u32 s95, s46, 524288
s_cmp_lg_u32 s95, 2
s_nop 1
s_cbranch_scc1 L_p0_spin
s_branch L_p0_ok
L_p1_spin:
s_cmp_eq_u32 s34, 0
s_cbranch_scc1 L_p1_ok
s_sub_u32 s34, s34, 1
s_load_dword s46, s[80:81], s27 glc
s_waitcnt lgkmcnt(0)
s_bfe_u32 s95, s46, 524296
s_cmp_lg_u32 s95, 2
s_nop 1
s_cbranch_scc1 L_p1_spin
s_branch L_p1_ok
L_p2_spin:
s_cmp_eq_u32 s34, 0
s_cbranch_scc1 L_p2_ok
s_sub_u32 s34, s34, 1
s_load_dword s46, s[80:81], s27 glc
s_waitcnt lgkmcnt(0)
s_bfe_u32 s95, s46, 524304
s_cmp_lg_u32 s95, 2
s_nop 1
s_cbranch_scc1 L_p2_spin
s_branch L_p2_ok
L_helper:
    s_and_b32 s13, s2, 1
    s_mul_i32 s13, s13, 3
    s_lshr_b32 s14, s2, 3
    s_add_u32 s4, s13, s14
    s_bfe_u32 s5, s2, 0x20001
    v_min_u32 v14, 55, v0
    v_lshrrev_b32 v12, 1, v14
    v_lshlrev_b32 v14, 7, v14
    s_and_b32 s15, s3, 1
    s_lshl1_add_u32 s15, s4, s15
    s_mul_i32 s15, s15, 28672
    s_mov_b32 s58, 401408
    s_mov_b32 s59, 0x20000
    s_cmp_lt_u32 s3, 2
    s_waitcnt lgkmcnt(0)
    s_cselect_b32 s56, s22, s24
    s_cselect_b32 s57, s23, s25
    s_mov_b64 s[80:81], s[46:47]
    s_mov_b32 s82, 172032
    s_mov_b32 s83, 0x20000
    s_lshl2_add_u32 s13, s2, s3
    s_cmp_lt_u32 s13, 112
    s_cselect_b32 s14, -1, 0
    s_lshl_b32 s13, s13, 10
    v_lshl_add_u32 v1, v0, 4, s13
    v_add_u32 v2, 0x20000, v1
    v_mov_b32 v4, s14
    v_mov_b32 v8, 0
    v_mov_b32 v5, s14
    v_mov_b32 v9, 0
    v_mov_b32 v6, s14
    v_mov_b32 v10, 0
    v_mov_b32 v7, s14
    v_mov_b32 v11, 0
    buffer_store_dwordx4 v[4:7], v1, s[80:83], 0 offen sc1
    buffer_store_dwordx4 v[8:11], v2, s[80:83], 0 offen sc1
    s_add_u32 s13, s5, 0
    s_and_b32 s13, s13, 3
    s_mul_i32 s13, s13, 7168
    s_add_u32 s13, s13, s15
    buffer_load_dword v20, v14, s[56:59], s13 offen
    s_waitcnt vmcnt(1)
    s_barrier
    s_cmp_lg_u32 s3, 0
    s_cbranch_scc1 L_h_nosig
    s_mov_b32 s6, 1
    s_atomic_add s6, s[44:45], 0
L_h_nosig:
    s_add_u32 s13, s5, 0
    s_and_b32 s13, s13, 3
    s_mov_b32 s70, 1605632
    s_mov_b32 s71, 0x20000
    s_mov_b64 s[68:69], s[36:37]
    s_mul_i32 s14, s3, 28
    v_add_u32 v12, s14, v12
    v_mul_u32_u24 v12, 3584, v12
    v_and_b32 v13, 1, v0
    v_lshl_add_u32 v12, v13, 7, v12
    s_mul_i32 s13, s13, 401408
    s_lshl_b32 s14, s4, 9
    s_add_u32 s13, s13, s14
    buffer_load_dword v21, v12, s[68:71], s13 offen offset:0
    s_add_u32 s13, s5, 1
    s_and_b32 s13, s13, 3
    s_mul_i32 s13, s13, 401408
    s_lshl_b32 s14, s4, 9
    s_add_u32 s13, s13, s14
    buffer_load_dword v22, v12, s[68:71], s13 offen offset:0
    s_add_u32 s13, s5, 2
    s_and_b32 s13, s13, 3
    s_mul_i32 s13, s13, 401408
    s_lshl_b32 s14, s4, 9
    s_add_u32 s13, s13, s14
    buffer_load_dword v23, v12, s[68:71], s13 offen offset:0
    s_add_u32 s13, s5, 3
    s_and_b32 s13, s13, 3
    s_mul_i32 s13, s13, 401408
    s_lshl_b32 s14, s4, 9
    s_add_u32 s13, s13, s14
    buffer_load_dword v24, v12, s[68:71], s13 offen offset:0
    s_add_u32 s13, s5, 0
    s_and_b32 s13, s13, 3
    s_mul_i32 s13, s13, 401408
    s_lshl_b32 s14, s4, 9
    s_add_u32 s13, s13, s14
    buffer_load_dword v25, v12, s[68:71], s13 offen offset:256
    s_mov_b32 s74, 1605632
    s_mov_b32 s75, 0x20000
    s_mov_b32 s54, 401408
    s_mov_b32 s55, 0x20000
    s_mov_b64 s[72:73], s[40:41]
    s_cmp_eq_u32 s3, 2
    s_cselect_b32 s52, s26, s28
    s_cselect_b32 s53, s27, s29
    v_mul_u32_u24 v13, 896, v0
    s_cmp_ge_u32 s3, 2
    s_cbranch_scc1 L_h_c
    s_add_u32 s15, s4, s3
    s_add_u32 s15, s15, 1
    s_cmp_ge_u32 s15, 7
    s_cselect_b32 s95, 7, 0
    s_sub_u32 s15, s15, s95
    s_lshl_b32 s15, s15, 7
    s_add_u32 s13, s5, 0
    s_and_b32 s13, s13, 3
    s_lshl2_add_u32 s13, s4, s13
    s_mul_i32 s13, s13, 57344
    s_add_u32 s13, s13, s15
    buffer_load_dword v26, v13, s[72:75], s13 offen
    s_add_u32 s13, s5, 1
    s_and_b32 s13, s13, 3
    s_lshl2_add_u32 s13, s4, s13
    s_mul_i32 s13, s13, 57344
    s_add_u32 s13, s13, s15
    buffer_load_dword v27, v13, s[72:75], s13 offen
    s_barrier
    s_add_u32 s13, s5, 2
    s_and_b32 s13, s13, 3
    s_lshl2_add_u32 s13, s4, s13
    s_mul_i32 s13, s13, 57344
    s_add_u32 s13, s13, s15
    buffer_load_dword v28, v13, s[72:75], s13 offen
    s_add_u32 s13, s5, 3
    s_and_b32 s13, s13, 3
    s_lshl2_add_u32 s13, s4, s13
    s_mul_i32 s13, s13, 57344
    s_add_u32 s13, s13, s15
    buffer_load_dword v29, v13, s[72:75], s13 offen
    s_barrier
    s_add_u32 s15, s4, s3
    s_add_u32 s15, s15, 3
    s_cmp_ge_u32 s15, 7
    s_cselect_b32 s95, 7, 0
    s_sub_u32 s15, s15, s95
    s_lshl_b32 s15, s15, 7
    s_add_u32 s13, s5, 0
    s_and_b32 s13, s13, 3
    s_lshl2_add_u32 s13, s4, s13
    s_mul_i32 s13, s13, 57344
    s_add_u32 s13, s13, s15
    buffer_load_dword v30, v13, s[72:75], s13 offen
    s_add_u32 s13, s5, 1
    s_and_b32 s13, s13, 3
    s_lshl2_add_u32 s13, s4, s13
    s_mul_i32 s13, s13, 57344
    s_add_u32 s13, s13, s15
    buffer_load_dword v31, v13, s[72:75], s13 offen
    s_barrier
    s_add_u32 s13, s5, 2
    s_and_b32 s13, s13, 3
    s_lshl2_add_u32 s13, s4, s13
    s_mul_i32 s13, s13, 57344
    s_add_u32 s13, s13, s15
    buffer_load_dword v32, v13, s[72:75], s13 offen
    s_add_u32 s13, s5, 3
    s_and_b32 s13, s13, 3
    s_lshl2_add_u32 s13, s4, s13
    s_mul_i32 s13, s13, 57344
    s_add_u32 s13, s13, s15
    buffer_load_dword v33, v13, s[72:75], s13 offen
    s_barrier
    s_add_u32 s15, s4, s3
    s_add_u32 s15, s15, 5
    s_cmp_ge_u32 s15, 7
    s_cselect_b32 s95, 7, 0
    s_sub_u32 s15, s15, s95
    s_lshl_b32 s15, s15, 7
    s_add_u32 s13, s5, 0
    s_and_b32 s13, s13, 3
    s_lshl2_add_u32 s13, s4, s13
    s_mul_i32 s13, s13, 57344
    s_add_u32 s13, s13, s15
    buffer_load_dword v34, v13, s[72:75], s13 offen
    s_add_u32 s13, s5, 1
    s_and_b32 s13, s13, 3
    s_lshl2_add_u32 s13, s4, s13
    s_mul_i32 s13, s13, 57344
    s_add_u32 s13, s13, s15
    buffer_load_dword v35, v13, s[72:75], s13 offen
    s_barrier
    s_add_u32 s13, s5, 2
    s_and_b32 s13, s13, 3
    s_lshl2_add_u32 s13, s4, s13
    s_mul_i32 s13, s13, 57344
    s_add_u32 s13, s13, s15
    buffer_load_dword v36, v13, s[72:75], s13 offen
    s_add_u32 s13, s5, 3
    s_and_b32 s13, s13, 3
    s_lshl2_add_u32 s13, s4, s13
    s_mul_i32 s13, s13, 57344
    s_add_u32 s13, s13, s15
    buffer_load_dword v37, v13, s[72:75], s13 offen
    s_barrier
    s_mov_b32 s15, s4
    s_lshl1_add_u32 s5, s3, s5
    s_lshl_b32 s15, s15, 7
    s_add_u32 s13, s5, 0
    s_and_b32 s13, s13, 3
    s_lshl2_add_u32 s13, s4, s13
    s_mul_i32 s13, s13, 57344
    s_add_u32 s13, s13, s15
    buffer_load_dword v38, v13, s[72:75], s13 offen
    s_add_u32 s13, s5, 1
    s_and_b32 s13, s13, 3
    s_lshl2_add_u32 s13, s4, s13
    s_mul_i32 s13, s13, 57344
    s_add_u32 s13, s13, s15
    buffer_load_dword v39, v13, s[72:75], s13 offen
    s_barrier
    s_waitcnt vmcnt(0) lgkmcnt(0)
    s_endpgm
L_h_c:
    s_add_u32 s15, s5, 0
    s_and_b32 s15, s15, 1
    s_add_u32 s15, s15, s4
    s_add_u32 s15, s15, 1
    s_cmp_ge_u32 s15, 7
    s_cselect_b32 s95, 7, 0
    s_sub_u32 s15, s15, s95
    s_mul_i32 s13, s15, 57344
    s_lshl_b32 s14, s4, 7
    s_add_u32 s13, s13, s14
    buffer_load_dword v40, v13, s[52:55], s13 offen
    s_barrier
    s_add_u32 s15, s5, 1
    s_and_b32 s15, s15, 1
    s_add_u32 s15, s15, s4
    s_add_u32 s15, s15, 1
    s_cmp_ge_u32 s15, 7
    s_cselect_b32 s95, 7, 0
    s_sub_u32 s15, s15, s95
    s_mul_i32 s13, s15, 57344
    s_lshl_b32 s14, s4, 7
    s_add_u32 s13, s13, s14
    buffer_load_dword v41, v13, s[52:55], s13 offen
    s_barrier
    s_add_u32 s15, s5, 2
    s_and_b32 s15, s15, 1
    s_add_u32 s15, s15, s4
    s_add_u32 s15, s15, 3
    s_cmp_ge_u32 s15, 7
    s_cselect_b32 s95, 7, 0
    s_sub_u32 s15, s15, s95
    s_mul_i32 s13, s15, 57344
    s_lshl_b32 s14, s4, 7
    s_add_u32 s13, s13, s14
    buffer_load_dword v42, v13, s[52:55], s13 offen
    s_barrier
    s_add_u32 s15, s5, 3
    s_and_b32 s15, s15, 1
    s_add_u32 s15, s15, s4
    s_add_u32 s15, s15, 3
    s_cmp_ge_u32 s15, 7
    s_cselect_b32 s95, 7, 0
    s_sub_u32 s15, s15, s95
    s_mul_i32 s13, s15, 57344
    s_lshl_b32 s14, s4, 7
    s_add_u32 s13, s13, s14
    buffer_load_dword v43, v13, s[52:55], s13 offen
    s_barrier
    s_add_u32 s15, s5, 4
    s_and_b32 s15, s15, 1
    s_add_u32 s15, s15, s4
    s_add_u32 s15, s15, 5
    s_cmp_ge_u32 s15, 7
    s_cselect_b32 s95, 7, 0
    s_sub_u32 s15, s15, s95
    s_mul_i32 s13, s15, 57344
    s_lshl_b32 s14, s4, 7
    s_add_u32 s13, s13, s14
    buffer_load_dword v44, v13, s[52:55], s13 offen
    s_barrier
    s_add_u32 s15, s5, 5
    s_and_b32 s15, s15, 1
    s_add_u32 s15, s15, s4
    s_add_u32 s15, s15, 5
    s_cmp_ge_u32 s15, 7
    s_cselect_b32 s95, 7, 0
    s_sub_u32 s15, s15, s95
    s_mul_i32 s13, s15, 57344
    s_lshl_b32 s14, s4, 7
    s_add_u32 s13, s13, s14
    buffer_load_dword v45, v13, s[52:55], s13 offen
    s_barrier
    s_mov_b32 s15, s4
    s_mul_i32 s13, s15, 57344
    s_lshl_b32 s14, s4, 7
    s_add_u32 s13, s13, s14
    buffer_load_dword v46, v13, s[52:55], s13 offen
    s_barrier
    s_waitcnt vmcnt(0) lgkmcnt(0)
    s_endpgm
L_end:
.section .rodata,"a"
.p2align 6
.amdhsa_kernel parallel_sum__ssm_conv_s5__dense_activation_mish__prompt_kernel
  .amdhsa_next_free_vgpr 512
  .amdhsa_next_free_sgpr 102
  .amdhsa_accum_offset 256
  .amdhsa_group_segment_fixed_size 0
  .amdhsa_kernarg_size 128
  .amdhsa_user_sgpr_count 2
  .amdhsa_user_sgpr_kernarg_segment_ptr 1
  .amdhsa_system_sgpr_workgroup_id_x 1
  .amdhsa_float_denorm_mode_32 3
.end_amdhsa_kernel
```
